```python
import torch

def _softmax(x, axis=-1):
    return torch.softmax(x, dim=axis)
def _gelu(x):
    return torch.nn.functional.gelu(x, approximate="tanh")
def _silu(x):
    return torch.nn.functional.silu(x)
def _sigmoid(x):
    return torch.sigmoid(x)
def _layernorm(x, axis=-1, eps=1e-5):
    m = x.mean(dim=axis, keepdim=True)
    v = x.var(dim=axis, keepdim=True, unbiased=False)
    return (x - m) / torch.sqrt(v + eps)
def _scatter_add(tgt, idx, src, axis=0):
    return tgt.clone().index_add_(axis, idx, src)
def _segment_sum(src, seg, n):
    out = torch.zeros((n,) + src.shape[1:], dtype=src.dtype)
    return out.index_add_(0, seg, src)
def _pad(x, pw):
    flat = tuple(v for pair in reversed(pw) for v in pair)
    return torch.nn.functional.pad(x, flat)

kernel_name = 'concat_heads__compressed_kv_cla__compressed_kv_cla__decode'

def setup_inputs():

    _w = (lambda a: (lambda t: t.to(torch.bfloat16) if t.is_floating_point() else t)(torch.as_tensor(a)))
    def _A_setup():
        B, H, Sq, Sk, D, M = 1, 32, 1, 4096, 128, 640
        Dc = 4 * D
        return {
            "x": _w((lambda *s: torch.randn(*s, dtype=torch.bfloat16) * 3.2)(B, Sq, M)),
            "c_kv": _w((lambda *s: torch.randn(*s, dtype=torch.bfloat16) * 0.05)(B, Sk, Dc)),
            "w_q": _w((lambda *s: torch.randn(*s, dtype=torch.bfloat16) * 3.2)(M, H, D) * (M ** -0.5)),
            "w_uk": _w((lambda *s: torch.randn(*s, dtype=torch.bfloat16) * 3.2)(Dc, H, D) * (Dc ** -0.5)),
            "w_uv": _w((lambda *s: torch.randn(*s, dtype=torch.bfloat16) * 0.05)(Dc, H, D) * (Dc ** -0.5)),
            "w_o": _w((lambda *s: torch.randn(*s, dtype=torch.bfloat16) * 0.05)(H, D, M) * ((H * D) ** -0.5)),
        }
    _A_in = _A_setup()

    def _B_setup():
        B, H, Sq, Sk, D, M = 1, 32, 1, 4096, 128, 640
        Dc = 4 * D
        return {
            "x": _w((lambda *s: torch.randn(*s, dtype=torch.bfloat16) * 3.2)(B, Sq, M)),
            "c_kv": _w((lambda *s: torch.randn(*s, dtype=torch.bfloat16) * 0.05)(B, Sk, Dc)),
            "w_q": _w((lambda *s: torch.randn(*s, dtype=torch.bfloat16) * 3.2)(M, H, D) * (M ** -0.5)),
            "w_uk": _w((lambda *s: torch.randn(*s, dtype=torch.bfloat16) * 3.2)(Dc, H, D) * (Dc ** -0.5)),
            "w_uv": _w((lambda *s: torch.randn(*s, dtype=torch.bfloat16) * 0.05)(Dc, H, D) * (Dc ** -0.5)),
            "w_o": _w((lambda *s: torch.randn(*s, dtype=torch.bfloat16) * 0.05)(H, D, M) * ((H * D) ** -0.5)),
        }
    _B_in = _B_setup()

    return {
        "A_x": _A_in["x"],
        "A_c_kv": _A_in["c_kv"],
        "A_w_q": _A_in["w_q"],
        "A_w_uk": _A_in["w_uk"],
        "A_w_uv": _A_in["w_uv"],
        "A_w_o": _A_in["w_o"],
        "B_x": _B_in["x"],
        "B_c_kv": _B_in["c_kv"],
        "B_w_q": _B_in["w_q"],
        "B_w_uk": _B_in["w_uk"],
        "B_w_uv": _B_in["w_uv"],
        "B_w_o": _B_in["w_o"],
    }

def reference(A_x, A_c_kv, A_w_q, A_w_uk, A_w_uv, A_w_o, B_x, B_c_kv, B_w_q, B_w_uk, B_w_uv, B_w_o):
    def _A_ref(x, c_kv, w_q, w_uk, w_uv, w_o):
        B, Sq, M = x.shape[0], x.shape[1], x.shape[2]
        Sk = c_kv.shape[1]
        H, D = w_q.shape[1], w_q.shape[2]
        q = torch.einsum("bqm,mhd->bhqd", x, w_q)
        k = torch.einsum("bkc,chd->bhkd", c_kv, w_uk)
        v = torch.einsum("bkc,chd->bhkd", c_kv, w_uv)
        scores = torch.einsum("bhqd,bhkd->bhqk", q, k) * (D ** -0.5)
        off = Sk - Sq
        qi = torch.arange(Sq)[:, None]
        kj = torch.arange(Sk)[None, :]
        cmask = kj <= (qi + off)
        scores = torch.where(cmask[None, None], scores, -1e9)
        p = _softmax(scores, axis=-1)
        ctx = torch.einsum("bhqk,bhkd->bhqd", p, v)
        return torch.einsum("bhqd,hdm->bqm", ctx, w_o)

    def _B_ref(x, c_kv, w_q, w_uk, w_uv, w_o):
        B, Sq, M = x.shape[0], x.shape[1], x.shape[2]
        Sk = c_kv.shape[1]
        H, D = w_q.shape[1], w_q.shape[2]
        q = torch.einsum("bqm,mhd->bhqd", x, w_q)
        k = torch.einsum("bkc,chd->bhkd", c_kv, w_uk)
        v = torch.einsum("bkc,chd->bhkd", c_kv, w_uv)
        scores = torch.einsum("bhqd,bhkd->bhqk", q, k) * (D ** -0.5)
        off = Sk - Sq
        qi = torch.arange(Sq)[:, None]
        kj = torch.arange(Sk)[None, :]
        cmask = kj <= (qi + off)
        scores = torch.where(cmask[None, None], scores, -1e9)
        p = _softmax(scores, axis=-1)
        ctx = torch.einsum("bhqk,bhkd->bhqd", p, v)
        return torch.einsum("bhqd,hdm->bqm", ctx, w_o)

    a = _A_ref(A_x, A_c_kv, A_w_q, A_w_uk, A_w_uv, A_w_o)
    b = _B_ref(B_x, B_c_kv, B_w_q, B_w_uk, B_w_uv, B_w_o)
    return torch.concatenate([a, b], axis=-1)
```

```asm
; @launch grid=(256,1,1) block=(256,1,1) lds=154880
.amdgcn_target "amdgcn-amd-amdhsa--gfx950"
.text
.globl concat_heads__compressed_kv_cla__compressed_kv_cla__decode_kernel
.p2align 8
.type concat_heads__compressed_kv_cla__compressed_kv_cla__decode_kernel,@function
concat_heads__compressed_kv_cla__compressed_kv_cla__decode_kernel:
    s_lshr_b32 s5, s2, 3
    s_add_u32 s6, s2, s5
    s_bfe_u32 s4, s6, 0x10002
    s_mul_i32 s7, s4, 48
    s_load_dwordx8 s[36:43], s[0:1], s7 offset:0
    s_cmp_ge_u32 s2, 256
    s_cbranch_scc1 L_end
    v_lshrrev_b32 v4, 6, v0
    s_and_b32 s6, s6, 3
    v_readfirstlane_b32 s3, v4
    v_and_b32 v0, 63, v0
    v_and_b32 v1, 15, v0
    v_lshrrev_b32 v2, 4, v0
    s_mov_b32 s10, 1280
    s_mov_b32 s11, 0x20000
    s_mov_b32 s14, 5242880
    s_mov_b32 s15, 0x20000
    s_lshl_b32 s57, s5, 8
    s_mul_i32 s54, s6, 160
    s_mul_i32 s55, s3, 40
    s_add_u32 s54, s54, s55
    s_lshl_b32 s58, s54, 1
    s_lshl_b32 s59, s54, 13
    s_add_u32 s59, s59, s57
    v_mul_u32_u24 v3, 81920, v2
    v_lshl_add_u32 v3, v1, 4, v3
    v_mul_u32_u24 v4, 20, v2
    s_waitcnt lgkmcnt(0)
    s_mov_b32 s12, s40
    s_mov_b32 s13, s41
    s_mov_b32 s8, s36
    s_mov_b32 s9, s37
    buffer_load_dwordx4 v[152:155], v3, s[12:15], s59 offen nt
    s_add_u32 s59, s59, 8192
    buffer_load_dwordx4 v[192:195], v4, s[8:11], s58 offen
    buffer_load_dword v196, v4, s[8:11], s58 offen offset:16
    buffer_load_dwordx4 v[156:159], v3, s[12:15], s59 offen nt
    s_add_u32 s59, s59, 8192
    buffer_load_dwordx4 v[160:163], v3, s[12:15], s59 offen nt
    s_add_u32 s59, s59, 8192
    buffer_load_dwordx4 v[164:167], v3, s[12:15], s59 offen nt
    s_add_u32 s59, s59, 8192
    buffer_load_dwordx4 v[168:171], v3, s[12:15], s59 offen nt
    s_add_u32 s59, s59, 8192
    buffer_load_dwordx4 v[172:175], v3, s[12:15], s59 offen nt
    s_add_u32 s59, s59, 8192
    s_load_dwordx4 s[20:23], s[0:1], s7 offset:32
    s_load_dwordx4 s[32:35], s[0:1], 96
    s_load_dwordx2 s[28:29], s[0:1], 112
    s_getpc_b64 s[64:65]
L_pc:
    s_sub_u32 s64, s64, L_pc-concat_heads__compressed_kv_cla__compressed_kv_cla__decode_kernel
    s_subb_u32 s65, s65, 0
    s_lshl_b32 s55, s5, 2
    s_add_u32 s55, s55, s3
    s_lshl_b32 s55, s55, 7
    s_min_u32 s55, s55, L_end-concat_heads__compressed_kv_cla__compressed_kv_cla__decode_kernel-64
    v_mov_b32 v112, -1
    v_mov_b32 v113, -1
    v_mov_b32 v114, -1
    v_mov_b32 v115, -1
    v_lshlrev_b32 v6, 4, v0
    s_lshl_b32 s61, s4, 5
    s_add_u32 s61, s61, s5
    s_lshl_b32 s56, s4, 7
    s_add_u32 s56, s56, 65536
    s_mov_b32 s16, s42
    s_mov_b32 s17, s43
    s_mov_b32 s18, 4194304
    s_mov_b32 s19, 0x20000
    s_mov_b32 s30, 9437184
    s_mov_b32 s31, 0x20000
    v_lshlrev_b32 v5, 13, v2
    v_lshrrev_b32 v139, 1, v2
    v_xor_b32 v139, v139, v1
    s_lshl_b32 s54, s6, 7
    s_lshl_b32 s44, s3, 5
    s_add_u32 s54, s54, s44
    s_lshl_b32 s54, s54, 13
    s_add_u32 s44, s54, s57
    s_lshl_b32 s45, s3, 13
    s_add_u32 s45, s45, 89344
    v_lshlrev_b32 v138, 9, v1
    v_add_u32 v138, s45, v138
    v_add_u32 v137, 0, v2
    v_xor_b32 v137, v137, v1
    v_lshl_add_u32 v144, v137, 4, v138
    v_add_u32 v137, 4, v2
    v_xor_b32 v137, v137, v1
    v_lshl_add_u32 v145, v137, 4, v138
    v_add_u32 v137, 8, v2
    v_xor_b32 v137, v137, v1
    v_lshl_add_u32 v146, v137, 4, v138
    v_add_u32 v137, 12, v2
    v_xor_b32 v137, v137, v1
    v_lshl_add_u32 v147, v137, 4, v138
    v_mov_b32 v120, 0
    v_mov_b32 v121, 0
    v_mov_b32 v122, 0
    v_mov_b32 v123, 0
    v_mov_b32 v124, 0
    v_mov_b32 v125, 0
    v_mov_b32 v126, 0
    v_mov_b32 v127, 0
    s_waitcnt lgkmcnt(0)
    s_load_dwordx2 s[52:53], s[28:29], s56
    s_load_dword s66, s[64:65], s55 offset:0
    s_load_dword s67, s[64:65], s55 offset:64
    s_mov_b32 s24, s22
    s_mov_b32 s25, s23
    s_mov_b32 s26, 5242880
    s_mov_b32 s27, 0x20000
    s_mov_b32 s22, 4194304
    s_mov_b32 s23, 0x20000
    s_mov_b32 s50, s34
    s_mov_b32 s51, s35
    s_mov_b32 s34, 2560
    s_mov_b32 s35, 0x20000
    s_lshl_b32 s63, s6, 3
    s_or_b32 s63, s63, s5
    s_cmp_lt_u32 s6, 2
    s_cbranch_scc1 L_setC
    s_mov_b32 s20, s38
    s_mov_b32 s21, s39
    s_lshl_b32 s46, s5, 1
    s_add_u32 s46, s46, s6
    s_sub_u32 s46, s46, 2
    s_mul_i32 s40, s3, 16896
    s_add_u32 s40, s40, 5376
    s_lshl_b32 s41, s46, 16
    s_lshl_b32 s54, s3, 14
    s_add_u32 s41, s41, s54
    s_mov_b32 s42, 1056
    s_mov_b32 s43, 1024
    v_mov_b32 v140, v6
    v_mov_b32 v141, v6
    v_mov_b32 v142, v6
    v_mov_b32 v143, v6
    s_branch L_set_done
L_setC:
    s_lshl_b32 s54, s61, 1
    s_add_u32 s54, s54, s6
    s_mul_i32 s62, s54, 2560
    s_add_u32 s62, s62, 98304
    s_mul_i32 s55, s3, 640
    s_add_u32 s54, s62, s55
    s_mov_b32 exec_lo, 0xffffffff
    s_mov_b32 exec_hi, 0xff
    buffer_store_dwordx4 v[112:115], v6, s[28:31], s54 offen sc1
    s_mov_b64 exec, -1
    s_lshl_b32 s40, s3, 14
    s_add_u32 s40, s40, 5376
    s_lshl_b32 s41, s3, 20
    s_add_u32 s41, s41, s57
    s_lshl_b32 s54, s6, 7
    s_add_u32 s41, s41, s54
    s_mov_b32 s42, 1024
    s_mov_b32 s43, 65536
    v_and_b32 v7, 7, v0
    v_lshrrev_b32 v8, 3, v0
    v_lshlrev_b32 v8, 13, v8
    v_xor_b32 v9, 0, v7
    v_lshl_add_u32 v140, v9, 4, v8
    v_xor_b32 v9, 2, v7
    v_lshl_add_u32 v141, v9, 4, v8
    v_xor_b32 v9, 4, v7
    v_lshl_add_u32 v142, v9, 4, v8
    v_xor_b32 v9, 6, v7
    v_lshl_add_u32 v143, v9, 4, v8
    s_cmp_ge_u32 s63, 8
    s_cbranch_scc1 L_set_done
    s_lshl_b32 s54, s4, 3
    s_add_u32 s54, s54, s5
    s_lshl_b32 s54, s54, 12
    s_lshl_b32 s55, s3, 10
    s_add_u32 s54, s54, s55
    buffer_store_dwordx4 v[112:115], v6, s[28:31], s54 offen sc1
L_set_done:
    s_waitcnt vmcnt(5)
    buffer_load_dwordx4 v[176:179], v3, s[12:15], s59 offen nt
    s_add_u32 s59, s59, 8192
    v_lshlrev_b32 v204, 16, v192
    v_and_b32 v205, 0xffff0000, v192
    v_lshlrev_b32 v206, 16, v193
    v_and_b32 v207, 0xffff0000, v193
    v_lshlrev_b32 v208, 16, v194
    v_and_b32 v209, 0xffff0000, v194
    v_lshlrev_b32 v210, 16, v195
    v_and_b32 v211, 0xffff0000, v195
    v_lshlrev_b32 v212, 16, v196
    v_and_b32 v213, 0xffff0000, v196
    v_lshlrev_b32 v128, 16, v152
    v_and_b32 v129, 0xffff0000, v152
    v_lshlrev_b32 v130, 16, v153
    v_and_b32 v131, 0xffff0000, v153
    v_lshlrev_b32 v132, 16, v154
    v_and_b32 v133, 0xffff0000, v154
    v_lshlrev_b32 v134, 16, v155
    v_and_b32 v135, 0xffff0000, v155
    v_pk_fma_f32 v[120:121], v[128:129], v[204:205], v[120:121] op_sel_hi:[1,0,1]
    v_pk_fma_f32 v[122:123], v[130:131], v[204:205], v[122:123] op_sel_hi:[1,0,1]
    v_pk_fma_f32 v[124:125], v[132:133], v[204:205], v[124:125] op_sel_hi:[1,0,1]
    v_pk_fma_f32 v[126:127], v[134:135], v[204:205], v[126:127] op_sel_hi:[1,0,1]
    s_waitcnt vmcnt(5)
    buffer_load_dwordx4 v[180:183], v3, s[12:15], s59 offen nt
    s_add_u32 s59, s59, 8192
    v_lshlrev_b32 v128, 16, v156
    v_and_b32 v129, 0xffff0000, v156
    v_lshlrev_b32 v130, 16, v157
    v_and_b32 v131, 0xffff0000, v157
    v_lshlrev_b32 v132, 16, v158
    v_and_b32 v133, 0xffff0000, v158
    v_lshlrev_b32 v134, 16, v159
    v_and_b32 v135, 0xffff0000, v159
    v_pk_fma_f32 v[120:121], v[128:129], v[204:205], v[120:121] op_sel:[0,1,0] op_sel_hi:[1,1,1]
    v_pk_fma_f32 v[122:123], v[130:131], v[204:205], v[122:123] op_sel:[0,1,0] op_sel_hi:[1,1,1]
    v_pk_fma_f32 v[124:125], v[132:133], v[204:205], v[124:125] op_sel:[0,1,0] op_sel_hi:[1,1,1]
    v_pk_fma_f32 v[126:127], v[134:135], v[204:205], v[126:127] op_sel:[0,1,0] op_sel_hi:[1,1,1]
    s_waitcnt vmcnt(5)
    buffer_load_dwordx4 v[184:187], v3, s[12:15], s59 offen nt
    s_add_u32 s59, s59, 8192
    v_lshlrev_b32 v128, 16, v160
    v_and_b32 v129, 0xffff0000, v160
    v_lshlrev_b32 v130, 16, v161
    v_and_b32 v131, 0xffff0000, v161
    v_lshlrev_b32 v132, 16, v162
    v_and_b32 v133, 0xffff0000, v162
    v_lshlrev_b32 v134, 16, v163
    v_and_b32 v135, 0xffff0000, v163
    v_pk_fma_f32 v[120:121], v[128:129], v[206:207], v[120:121] op_sel_hi:[1,0,1]
    v_pk_fma_f32 v[122:123], v[130:131], v[206:207], v[122:123] op_sel_hi:[1,0,1]
    v_pk_fma_f32 v[124:125], v[132:133], v[206:207], v[124:125] op_sel_hi:[1,0,1]
    v_pk_fma_f32 v[126:127], v[134:135], v[206:207], v[126:127] op_sel_hi:[1,0,1]
    s_waitcnt vmcnt(5)
    buffer_load_dwordx4 v[188:191], v3, s[12:15], s59 offen nt
    s_cmp_ge_u32 s63, 8
    s_cbranch_scc1 L_noclr
    s_waitcnt vmcnt(4)
    s_barrier
    s_cmp_lg_u32 s3, 0
    s_cbranch_scc1 L_noclr
    v_mov_b32 v136, 0
    v_mov_b32 v137, 1
    s_mov_b64 exec, 1
    global_atomic_add v136, v137, s[50:51] sc1
    s_mov_b64 exec, -1
L_noclr:
    v_lshlrev_b32 v128, 16, v164
    v_and_b32 v129, 0xffff0000, v164
    v_lshlrev_b32 v130, 16, v165
    v_and_b32 v131, 0xffff0000, v165
    v_lshlrev_b32 v132, 16, v166
    v_and_b32 v133, 0xffff0000, v166
    v_lshlrev_b32 v134, 16, v167
    v_and_b32 v135, 0xffff0000, v167
    v_pk_fma_f32 v[120:121], v[128:129], v[206:207], v[120:121] op_sel:[0,1,0] op_sel_hi:[1,1,1]
    v_pk_fma_f32 v[122:123], v[130:131], v[206:207], v[122:123] op_sel:[0,1,0] op_sel_hi:[1,1,1]
    v_pk_fma_f32 v[124:125], v[132:133], v[206:207], v[124:125] op_sel:[0,1,0] op_sel_hi:[1,1,1]
    v_pk_fma_f32 v[126:127], v[134:135], v[206:207], v[126:127] op_sel:[0,1,0] op_sel_hi:[1,1,1]
    s_waitcnt vmcnt(5)
    v_xor_b32 v138, 0, v139
    s_mov_b32 m0, s45
    v_lshl_add_u32 v138, v138, 4, v5
    s_add_u32 s45, s45, 1024
    buffer_load_dwordx4 v138, s[16:19], s44 offen nt lds
    s_add_u32 s44, s44, 32768
    v_lshlrev_b32 v128, 16, v168
    v_and_b32 v129, 0xffff0000, v168
    v_lshlrev_b32 v130, 16, v169
    v_and_b32 v131, 0xffff0000, v169
    v_lshlrev_b32 v132, 16, v170
    v_and_b32 v133, 0xffff0000, v170
    v_lshlrev_b32 v134, 16, v171
    v_and_b32 v135, 0xffff0000, v171
    v_pk_fma_f32 v[120:121], v[128:129], v[208:209], v[120:121] op_sel_hi:[1,0,1]
    v_pk_fma_f32 v[122:123], v[130:131], v[208:209], v[122:123] op_sel_hi:[1,0,1]
    v_pk_fma_f32 v[124:125], v[132:133], v[208:209], v[124:125] op_sel_hi:[1,0,1]
    v_pk_fma_f32 v[126:127], v[134:135], v[208:209], v[126:127] op_sel_hi:[1,0,1]
    s_waitcnt vmcnt(5)
    v_xor_b32 v138, 2, v139
    s_mov_b32 m0, s45
    v_lshl_add_u32 v138, v138, 4, v5
    s_add_u32 s45, s45, 1024
    buffer_load_dwordx4 v138, s[16:19], s44 offen nt lds
    s_add_u32 s44, s44, 32768
    v_lshlrev_b32 v128, 16, v172
    v_and_b32 v129, 0xffff0000, v172
    v_lshlrev_b32 v130, 16, v173
    v_and_b32 v131, 0xffff0000, v173
    v_lshlrev_b32 v132, 16, v174
    v_and_b32 v133, 0xffff0000, v174
    v_lshlrev_b32 v134, 16, v175
    v_and_b32 v135, 0xffff0000, v175
    v_pk_fma_f32 v[120:121], v[128:129], v[208:209], v[120:121] op_sel:[0,1,0] op_sel_hi:[1,1,1]
    v_pk_fma_f32 v[122:123], v[130:131], v[208:209], v[122:123] op_sel:[0,1,0] op_sel_hi:[1,1,1]
    v_pk_fma_f32 v[124:125], v[132:133], v[208:209], v[124:125] op_sel:[0,1,0] op_sel_hi:[1,1,1]
    v_pk_fma_f32 v[126:127], v[134:135], v[208:209], v[126:127] op_sel:[0,1,0] op_sel_hi:[1,1,1]
    s_waitcnt vmcnt(5)
    v_xor_b32 v138, 4, v139
    s_mov_b32 m0, s45
    v_lshl_add_u32 v138, v138, 4, v5
    s_add_u32 s45, s45, 1024
    buffer_load_dwordx4 v138, s[16:19], s44 offen nt lds
    s_add_u32 s44, s44, 32768
    v_lshlrev_b32 v128, 16, v176
    v_and_b32 v129, 0xffff0000, v176
    v_lshlrev_b32 v130, 16, v177
    v_and_b32 v131, 0xffff0000, v177
    v_lshlrev_b32 v132, 16, v178
    v_and_b32 v133, 0xffff0000, v178
    v_lshlrev_b32 v134, 16, v179
    v_and_b32 v135, 0xffff0000, v179
    v_pk_fma_f32 v[120:121], v[128:129], v[210:211], v[120:121] op_sel_hi:[1,0,1]
    v_pk_fma_f32 v[122:123], v[130:131], v[210:211], v[122:123] op_sel_hi:[1,0,1]
    v_pk_fma_f32 v[124:125], v[132:133], v[210:211], v[124:125] op_sel_hi:[1,0,1]
    v_pk_fma_f32 v[126:127], v[134:135], v[210:211], v[126:127] op_sel_hi:[1,0,1]
    s_waitcnt vmcnt(5)
    v_xor_b32 v138, 6, v139
    s_mov_b32 m0, s45
    v_lshl_add_u32 v138, v138, 4, v5
    s_add_u32 s45, s45, 1024
    buffer_load_dwordx4 v138, s[16:19], s44 offen nt lds
    s_add_u32 s44, s44, 32768
    v_lshlrev_b32 v128, 16, v180
    v_and_b32 v129, 0xffff0000, v180
    v_lshlrev_b32 v130, 16, v181
    v_and_b32 v131, 0xffff0000, v181
    v_lshlrev_b32 v132, 16, v182
    v_and_b32 v133, 0xffff0000, v182
    v_lshlrev_b32 v134, 16, v183
    v_and_b32 v135, 0xffff0000, v183
    v_pk_fma_f32 v[120:121], v[128:129], v[210:211], v[120:121] op_sel:[0,1,0] op_sel_hi:[1,1,1]
    v_pk_fma_f32 v[122:123], v[130:131], v[210:211], v[122:123] op_sel:[0,1,0] op_sel_hi:[1,1,1]
    v_pk_fma_f32 v[124:125], v[132:133], v[210:211], v[124:125] op_sel:[0,1,0] op_sel_hi:[1,1,1]
    v_pk_fma_f32 v[126:127], v[134:135], v[210:211], v[126:127] op_sel:[0,1,0] op_sel_hi:[1,1,1]
    s_waitcnt vmcnt(5)
    v_xor_b32 v138, 8, v139
    s_mov_b32 m0, s45
    v_lshl_add_u32 v138, v138, 4, v5
    s_add_u32 s45, s45, 1024
    buffer_load_dwordx4 v138, s[16:19], s44 offen nt lds
    s_add_u32 s44, s44, 32768
    v_lshlrev_b32 v128, 16, v184
    v_and_b32 v129, 0xffff0000, v184
    v_lshlrev_b32 v130, 16, v185
    v_and_b32 v131, 0xffff0000, v185
    v_lshlrev_b32 v132, 16, v186
    v_and_b32 v133, 0xffff0000, v186
    v_lshlrev_b32 v134, 16, v187
    v_and_b32 v135, 0xffff0000, v187
    v_pk_fma_f32 v[120:121], v[128:129], v[212:213], v[120:121] op_sel_hi:[1,0,1]
    v_pk_fma_f32 v[122:123], v[130:131], v[212:213], v[122:123] op_sel_hi:[1,0,1]
    v_pk_fma_f32 v[124:125], v[132:133], v[212:213], v[124:125] op_sel_hi:[1,0,1]
    v_pk_fma_f32 v[126:127], v[134:135], v[212:213], v[126:127] op_sel_hi:[1,0,1]
    s_waitcnt vmcnt(5)
    v_xor_b32 v138, 10, v139
    s_mov_b32 m0, s45
    v_lshl_add_u32 v138, v138, 4, v5
    s_add_u32 s45, s45, 1024
    buffer_load_dwordx4 v138, s[16:19], s44 offen nt lds
    s_add_u32 s44, s44, 32768
    v_lshlrev_b32 v128, 16, v188
    v_and_b32 v129, 0xffff0000, v188
    v_lshlrev_b32 v130, 16, v189
    v_and_b32 v131, 0xffff0000, v189
    v_lshlrev_b32 v132, 16, v190
    v_and_b32 v133, 0xffff0000, v190
    v_lshlrev_b32 v134, 16, v191
    v_and_b32 v135, 0xffff0000, v191
    v_pk_fma_f32 v[120:121], v[128:129], v[212:213], v[120:121] op_sel:[0,1,0] op_sel_hi:[1,1,1]
    v_pk_fma_f32 v[122:123], v[130:131], v[212:213], v[122:123] op_sel:[0,1,0] op_sel_hi:[1,1,1]
    v_pk_fma_f32 v[124:125], v[132:133], v[212:213], v[124:125] op_sel:[0,1,0] op_sel_hi:[1,1,1]
    v_pk_fma_f32 v[126:127], v[134:135], v[212:213], v[126:127] op_sel:[0,1,0] op_sel_hi:[1,1,1]
    v_permlane32_swap_b32 v120, v121
    v_permlane32_swap_b32 v122, v123
    v_permlane32_swap_b32 v124, v125
    v_permlane32_swap_b32 v126, v127
    v_and_b32 v136, 1, v2
    v_lshlrev_b32 v136, 1, v136
    v_lshrrev_b32 v137, 1, v2
    v_or_b32 v136, v136, v137
    v_add_f32 v120, v120, v121
    v_add_f32 v122, v122, v123
    v_add_f32 v124, v124, v125
    v_add_f32 v126, v126, v127
    v_lshl_add_u32 v136, v1, 3, v136
    v_lshlrev_b32 v136, 2, v136
    v_permlane16_swap_b32 v120, v122
    v_permlane16_swap_b32 v124, v126
    s_lshl_b32 s54, s3, 9
    v_add_u32 v136, s54, v136
    v_add_f32 v120, v120, v122
    v_add_f32 v124, v124, v126
    s_waitcnt lgkmcnt(0)
    s_add_u32 s52, s52, 1
    ds_write_b32 v136, v120 offset:0
    ds_write_b32 v136, v124 offset:16
    v_xor_b32 v138, 12, v139
    s_mov_b32 m0, s45
    v_lshl_add_u32 v138, v138, 4, v5
    s_add_u32 s45, s45, 1024
    buffer_load_dwordx4 v138, s[16:19], s44 offen nt lds
    s_add_u32 s44, s44, 32768
    v_xor_b32 v138, 14, v139
    s_mov_b32 m0, s45
    v_lshl_add_u32 v138, v138, 4, v5
    s_add_u32 s45, s45, 1024
    buffer_load_dwordx4 v138, s[16:19], s44 offen nt lds
    s_add_u32 s44, s44, 32768
    v_lshlrev_b32 v136, 3, v0
    v_mov_b32 v106, s52
    v_mov_b32 v107, s53
    s_lshl_b32 s60, s61, 12
    s_add_u32 s60, s60, 524288
    s_lshl_b32 s54, s6, 10
    s_add_u32 s54, s54, s60
    s_waitcnt lgkmcnt(0)
    s_barrier
    s_cmp_lg_u32 s3, 0
    s_cbranch_scc1 L_others
    ds_read_b64 v[112:113], v136 offset:0
    ds_read_b64 v[114:115], v136 offset:512
    ds_read_b64 v[116:117], v136 offset:1024
    ds_read_b64 v[118:119], v136 offset:1536
    s_mov_b32 s55, 0
    v_mov_b32 v9, 0
    s_waitcnt lgkmcnt(0)
    v_pk_add_f32 v[112:113], v[112:113], v[114:115]
    v_pk_add_f32 v[108:109], v[116:117], v[118:119]
    v_pk_add_f32 v[104:105], v[112:113], v[108:109]
    buffer_store_dwordx4 v[104:107], v6, s[28:31], s54 offen sc1
L_qs:
    s_load_dwordx2 s[64:65], s[28:29], s60 offset:1016 glc
    s_load_dwordx2 s[66:67], s[28:29], s60 offset:2040 glc
    s_load_dwordx2 s[68:69], s[28:29], s60 offset:3064 glc
    s_load_dwordx2 s[70:71], s[28:29], s60 offset:4088 glc
    s_add_u32 s55, s55, 1
    s_waitcnt lgkmcnt(0)
    s_xor_b64 s[64:65], s[64:65], s[52:53]
    s_xor_b64 s[66:67], s[66:67], s[52:53]
    s_xor_b64 s[68:69], s[68:69], s[52:53]
    s_xor_b64 s[70:71], s[70:71], s[52:53]
    s_or_b64 s[64:65], s[64:65], s[66:67]
    s_or_b64 s[68:69], s[68:69], s[70:71]
    s_cmp_ge_u32 s55, 200000
    s_cbranch_scc1 L_qg
    s_or_b64 s[64:65], s[64:65], s[68:69]
    s_cbranch_scc1 L_qs
L_qg:
    buffer_load_dwordx4 v[120:123], v6, s[28:31], s60 offen offset:0 sc1
    buffer_load_dwordx4 v[124:127], v6, s[28:31], s60 offen offset:1024 sc1
    buffer_load_dwordx4 v[128:131], v6, s[28:31], s60 offen offset:2048 sc1
    buffer_load_dwordx4 v[132:135], v6, s[28:31], s60 offen offset:3072 sc1
    global_load_dword v136, v9, s[50:51] sc1
    s_barrier
    s_mov_b32 m0, s40
    s_add_u32 s40, s40, s42
    buffer_load_dwordx4 v140, s[20:23], s41 offen nt lds
    s_add_u32 s41, s41, s43
    s_mov_b32 m0, s40
    s_add_u32 s40, s40, s42
    buffer_load_dwordx4 v140, s[20:23], s41 offen nt lds
    s_add_u32 s41, s41, s43
    s_mov_b32 m0, s40
    s_add_u32 s40, s40, s42
    buffer_load_dwordx4 v141, s[20:23], s41 offen nt lds
    s_add_u32 s41, s41, s43
    s_mov_b32 m0, s40
    s_add_u32 s40, s40, s42
    buffer_load_dwordx4 v141, s[20:23], s41 offen nt lds
    s_add_u32 s41, s41, s43
    s_waitcnt vmcnt(4)
L_qg_chk:
    v_min_u32 v136, 16, v136
    v_xor_b32 v136, 16, v136
    v_xor_b32 v122, s52, v122
    v_xor_b32 v123, s53, v123
    v_or3_b32 v136, v136, v122, v123
    v_xor_b32 v126, s52, v126
    v_xor_b32 v127, s53, v127
    v_or3_b32 v136, v136, v126, v127
    v_xor_b32 v130, s52, v130
    v_xor_b32 v131, s53, v131
    v_or3_b32 v136, v136, v130, v131
    v_xor_b32 v134, s52, v134
    v_xor_b32 v135, s53, v135
    v_or3_b32 v136, v136, v134, v135
    v_cmp_ne_u32 vcc, 0, v136
    s_cbranch_vccz L_qg_ok
    s_add_u32 s55, s55, 1
    s_cmp_ge_u32 s55, 200000
    s_cbranch_scc1 L_qg_ok
    buffer_load_dwordx4 v[120:123], v6, s[28:31], s60 offen offset:0 sc1
    buffer_load_dwordx4 v[124:127], v6, s[28:31], s60 offen offset:1024 sc1
    buffer_load_dwordx4 v[128:131], v6, s[28:31], s60 offen offset:2048 sc1
    buffer_load_dwordx4 v[132:135], v6, s[28:31], s60 offen offset:3072 sc1
    global_load_dword v136, v9, s[50:51] sc1
    s_waitcnt vmcnt(0)
    s_branch L_qg_chk
L_qg_ok:
    v_pk_add_f32 v[120:121], v[120:121], v[124:125]
    v_pk_add_f32 v[128:129], v[128:129], v[132:133]
    v_pk_add_f32 v[120:121], v[120:121], v[128:129]
    v_lshlrev_b32 v9, 2, v0
    v_cvt_pk_bf16_f32 v120, v120, v121
    ds_write_b32 v9, v120 offset:2048
    s_branch L_qx_done
L_others:
    s_barrier
    s_mov_b32 m0, s40
    s_add_u32 s40, s40, s42
    buffer_load_dwordx4 v140, s[20:23], s41 offen nt lds
    s_add_u32 s41, s41, s43
    s_mov_b32 m0, s40
    s_add_u32 s40, s40, s42
    buffer_load_dwordx4 v140, s[20:23], s41 offen nt lds
    s_add_u32 s41, s41, s43
    s_mov_b32 m0, s40
    s_add_u32 s40, s40, s42
    buffer_load_dwordx4 v141, s[20:23], s41 offen nt lds
    s_add_u32 s41, s41, s43
    s_mov_b32 m0, s40
    s_add_u32 s40, s40, s42
    buffer_load_dwordx4 v141, s[20:23], s41 offen nt lds
    s_add_u32 s41, s41, s43
    s_waitcnt vmcnt(4)
L_qx_done:
    ds_read_b128 v[32:35], v144 offset:0
    ds_read_b128 v[48:51], v144 offset:256
    ds_read_b128 v[36:39], v145 offset:0
    ds_read_b128 v[52:55], v145 offset:256
    ds_read_b128 v[40:43], v146 offset:0
    ds_read_b128 v[56:59], v146 offset:256
    ds_read_b128 v[44:47], v147 offset:0
    ds_read_b128 v[60:63], v147 offset:256
    v_lshlrev_b32 v9, 4, v2
    s_mov_b32 s54, 0x3e0293ee
    s_lshr_b32 s60, s61, 4
    s_lshl_b32 s60, s60, 4
    s_lshl_b32 s55, s6, 2
    s_add_u32 s55, s55, s3
    s_add_u32 s60, s60, s55
    s_lshl_b32 s60, s60, 10
    s_and_b32 s55, s5, 15
    s_lshl_b32 s55, s55, 6
    s_add_u32 s60, s60, s55
    v_lshlrev_b32 v8, 2, v0
    s_waitcnt lgkmcnt(0)
    s_barrier
    ds_read_b128 v[120:123], v9 offset:2048
    ds_read_b128 v[124:127], v9 offset:2112
    ds_read_b128 v[128:131], v9 offset:2176
    ds_read_b128 v[132:135], v9 offset:2240
    s_waitcnt lgkmcnt(3)
    v_mfma_f32_16x16x32_bf16 v[64:67], v[120:123], v[32:35], 0
    v_mfma_f32_16x16x32_bf16 v[68:71], v[120:123], v[48:51], 0
    s_waitcnt lgkmcnt(2)
    v_mfma_f32_16x16x32_bf16 v[64:67], v[124:127], v[36:39], v[64:67]
    v_mfma_f32_16x16x32_bf16 v[68:71], v[124:127], v[52:55], v[68:71]
    s_waitcnt lgkmcnt(1)
    v_mfma_f32_16x16x32_bf16 v[64:67], v[128:131], v[40:43], v[64:67]
    v_mfma_f32_16x16x32_bf16 v[68:71], v[128:131], v[56:59], v[68:71]
    s_waitcnt lgkmcnt(0)
    v_mfma_f32_16x16x32_bf16 v[64:67], v[132:135], v[44:47], v[64:67]
    v_mfma_f32_16x16x32_bf16 v[68:71], v[132:135], v[60:63], v[68:71]
    s_nop 6
    v_mul_f32 v64, s54, v64
    v_mul_f32 v68, s54, v68
    v_cvt_pk_bf16_f32 v64, v64, v68
    v_min_u32 v64, -2, v64
    s_mov_b32 exec_lo, 0xffff
    s_mov_b32 exec_hi, 0x0
    buffer_store_dword v64, v8, s[28:31], s60 offen sc1
    s_mov_b64 exec, -1
    s_cmp_lt_u32 s6, 2
    s_cbranch_scc1 L_roleC
    s_mov_b32 m0, s40
    s_add_u32 s40, s40, s42
    buffer_load_dwordx4 v142, s[20:23], s41 offen nt lds
    s_add_u32 s41, s41, s43
    s_mov_b32 m0, s40
    s_add_u32 s40, s40, s42
    buffer_load_dwordx4 v142, s[20:23], s41 offen nt lds
    s_add_u32 s41, s41, s43
    s_mov_b32 m0, s40
    s_add_u32 s40, s40, s42
    buffer_load_dwordx4 v143, s[20:23], s41 offen nt lds
    s_add_u32 s41, s41, s43
    s_mov_b32 m0, s40
    s_add_u32 s40, s40, s42
    buffer_load_dwordx4 v143, s[20:23], s41 offen nt lds
    s_add_u32 s41, s41, s43
    s_mov_b32 m0, s40
    s_add_u32 s40, s40, s42
    buffer_load_dwordx4 v140, s[20:23], s41 offen nt lds
    s_add_u32 s41, s41, s43
    s_mov_b32 m0, s40
    s_add_u32 s40, s40, s42
    buffer_load_dwordx4 v140, s[20:23], s41 offen nt lds
    s_add_u32 s41, s41, s43
    s_mov_b32 m0, s40
    s_add_u32 s40, s40, s42
    buffer_load_dwordx4 v141, s[20:23], s41 offen nt lds
    s_add_u32 s41, s41, s43
    s_mov_b32 m0, s40
    s_add_u32 s40, s40, s42
    buffer_load_dwordx4 v141, s[20:23], s41 offen nt lds
    s_add_u32 s41, s41, s43
    s_mov_b32 m0, s40
    s_add_u32 s40, s40, s42
    buffer_load_dwordx4 v142, s[20:23], s41 offen nt lds
    s_add_u32 s41, s41, s43
    s_mov_b32 m0, s40
    s_add_u32 s40, s40, s42
    buffer_load_dwordx4 v142, s[20:23], s41 offen nt lds
    s_add_u32 s41, s41, s43
    s_mov_b32 m0, s40
    s_add_u32 s40, s40, s42
    buffer_load_dwordx4 v143, s[20:23], s41 offen nt lds
    s_add_u32 s41, s41, s43
    s_mov_b32 m0, s40
    s_add_u32 s40, s40, s42
    buffer_load_dwordx4 v143, s[20:23], s41 offen nt lds
    s_add_u32 s41, s41, s43
    s_and_b32 s47, s3, 1
    s_lshr_b32 s48, s3, 1
    v_lshlrev_b32 v5, 6, v1
    v_lshl_add_u32 v5, v2, 4, v5
    s_lshl_b32 s54, s4, 15
    s_lshl_b32 s55, s47, 14
    s_add_u32 s54, s54, s55
    s_lshl_b32 s49, s48, 13
    s_add_u32 s60, s54, s49
    s_lshl_b32 s49, s48, 9
    s_add_u32 s62, s60, 4096
    s_add_u32 s54, s49, 5376
    v_mul_u32_u24 v7, 1056, v1
    v_lshl_add_u32 v7, v2, 4, v7
    v_add_u32 v7, s54, v7
    v_lshrrev_b32 v8, 2, v0
    v_mul_u32_u24 v8, 1056, v8
    v_and_b32 v10, 3, v0
    v_lshl_add_u32 v8, v10, 3, v8
    v_add_u32 v8, s54, v8
    s_lshl_b32 s54, s3, 12
    s_add_u32 s54, s54, 72960
    v_add_u32 v11, s54, v6
    s_xor_b32 s54, s3, 2
    s_lshl_b32 s54, s54, 12
    s_add_u32 s54, s54, 72960
    v_add_u32 v12, s54, v6
    v_lshlrev_b32 v13, 18, v2
    v_lshl_add_u32 v13, v1, 4, v13
    v_lshlrev_b32 v14, 10, v1
    s_lshl_b32 s54, s4, 5
    s_lshl_b32 s55, s47, 4
    s_add_u32 s54, s54, s55
    s_lshl_b32 s54, s54, 6
    s_add_u32 s54, s54, s46
    s_lshl_b32 s64, s54, 10
    s_add_u32 s64, s64, s49
    s_add_u32 s64, s64, 1048576
    s_add_u32 s65, s64, 65536
    s_add_u32 s66, s65, 65536
    s_add_u32 s67, s66, 65536
    s_lshl_b32 s68, s54, 4
    s_add_u32 s68, s68, 5242880
    s_mov_b32 s55, 0
    buffer_load_dwordx4 v[32:35], v5, s[28:31], s60 offen offset:0 sc1
    buffer_load_dwordx4 v[36:39], v5, s[28:31], s60 offen offset:1024 sc1
    buffer_load_dwordx4 v[40:43], v5, s[28:31], s60 offen offset:2048 sc1
    buffer_load_dwordx4 v[44:47], v5, s[28:31], s60 offen offset:3072 sc1
    buffer_load_dwordx4 v[48:51], v5, s[28:31], s62 offen offset:0 sc1
    buffer_load_dwordx4 v[52:55], v5, s[28:31], s62 offen offset:1024 sc1
    buffer_load_dwordx4 v[56:59], v5, s[28:31], s62 offen offset:2048 sc1
    buffer_load_dwordx4 v[60:63], v5, s[28:31], s62 offen offset:3072 sc1
    s_waitcnt vmcnt(0)
    v_max3_u32 v10, v32, v33, v34
    v_max3_u32 v108, v35, v36, v37
    v_max3_u32 v10, v10, v38, v39
    v_max3_u32 v108, v108, v40, v41
    v_max3_u32 v10, v10, v42, v43
    v_max3_u32 v108, v108, v44, v45
    v_max3_u32 v10, v10, v46, v47
    v_max3_u32 v108, v108, v48, v49
    v_max3_u32 v10, v10, v50, v51
    v_max3_u32 v108, v108, v52, v53
    v_max3_u32 v10, v10, v54, v55
    v_max3_u32 v108, v108, v56, v57
    v_max3_u32 v10, v10, v58, v59
    v_max3_u32 v108, v108, v60, v61
    v_max3_u32 v10, v10, v62, v63
    v_max_u32 v10, v10, v108
    v_cmp_eq_u32 vcc, -1, v10
    s_nop 0
    s_mov_b64 s[58:59], vcc
    s_cbranch_vccz L_qa_first_ok
    s_mov_b64 exec, vcc
    buffer_load_dwordx4 v[32:35], v5, s[28:31], s60 offen offset:0 sc1
    buffer_load_dwordx4 v[36:39], v5, s[28:31], s60 offen offset:1024 sc1
    buffer_load_dwordx4 v[40:43], v5, s[28:31], s60 offen offset:2048 sc1
    buffer_load_dwordx4 v[44:47], v5, s[28:31], s60 offen offset:3072 sc1
    buffer_load_dwordx4 v[48:51], v5, s[28:31], s62 offen offset:0 sc1
    buffer_load_dwordx4 v[52:55], v5, s[28:31], s62 offen offset:1024 sc1
    buffer_load_dwordx4 v[56:59], v5, s[28:31], s62 offen offset:2048 sc1
    buffer_load_dwordx4 v[60:63], v5, s[28:31], s62 offen offset:3072 sc1
    s_mov_b64 exec, -1
L_qa_first_ok:
    s_barrier
    ds_read_b128 a[0:3], v7 offset:0
    ds_read_b128 a[32:35], v7 offset:16896
    ds_read_b128 a[64:67], v7 offset:33792
    ds_read_b128 a[96:99], v7 offset:50688
    ds_read_b128 a[4:7], v7 offset:64
    ds_read_b128 a[36:39], v7 offset:16960
    ds_read_b128 a[68:71], v7 offset:33856
    ds_read_b128 a[100:103], v7 offset:50752
    ds_read_b128 a[8:11], v7 offset:128
    ds_read_b128 a[40:43], v7 offset:17024
    ds_read_b128 a[72:75], v7 offset:33920
    ds_read_b128 a[104:107], v7 offset:50816
    ds_read_b128 a[12:15], v7 offset:192
    ds_read_b128 a[44:47], v7 offset:17088
    ds_read_b128 a[76:79], v7 offset:33984
    ds_read_b128 a[108:111], v7 offset:50880
    ds_read_b128 a[16:19], v7 offset:256
    ds_read_b128 a[48:51], v7 offset:17152
    ds_read_b128 a[80:83], v7 offset:34048
    ds_read_b128 a[112:115], v7 offset:50944
    ds_read_b128 a[20:23], v7 offset:320
    ds_read_b128 a[52:55], v7 offset:17216
    ds_read_b128 a[84:87], v7 offset:34112
    ds_read_b128 a[116:119], v7 offset:51008
    ds_read_b128 a[24:27], v7 offset:384
    ds_read_b128 a[56:59], v7 offset:17280
    ds_read_b128 a[88:91], v7 offset:34176
    ds_read_b128 a[120:123], v7 offset:51072
    ds_read_b128 a[28:31], v7 offset:448
    ds_read_b128 a[60:63], v7 offset:17344
    ds_read_b128 a[92:95], v7 offset:34240
    ds_read_b128 a[124:127], v7 offset:51136
    s_cmp_eq_u64 s[58:59], 0
    s_cbranch_scc1 L_qa_ok
    s_mov_b64 exec, s[58:59]
L_qa_chk:
    s_waitcnt vmcnt(0)
    v_max3_u32 v10, v32, v33, v34
    v_max3_u32 v108, v35, v36, v37
    v_max3_u32 v10, v10, v38, v39
    v_max3_u32 v108, v108, v40, v41
    v_max3_u32 v10, v10, v42, v43
    v_max3_u32 v108, v108, v44, v45
    v_max3_u32 v10, v10, v46, v47
    v_max3_u32 v108, v108, v48, v49
    v_max3_u32 v10, v10, v50, v51
    v_max3_u32 v108, v108, v52, v53
    v_max3_u32 v10, v10, v54, v55
    v_max3_u32 v108, v108, v56, v57
    v_max3_u32 v10, v10, v58, v59
    v_max3_u32 v108, v108, v60, v61
    v_max3_u32 v10, v10, v62, v63
    v_max_u32 v10, v10, v108
    v_cmp_eq_u32 vcc, -1, v10
    s_cbranch_vccz L_qa_ok
    s_add_u32 s55, s55, 1
    s_cmp_ge_u32 s55, 200000
    s_cbranch_scc1 L_qa_ok
    s_mov_b64 exec, vcc
    buffer_load_dwordx4 v[32:35], v5, s[28:31], s60 offen offset:0 sc1
    buffer_load_dwordx4 v[36:39], v5, s[28:31], s60 offen offset:1024 sc1
    buffer_load_dwordx4 v[40:43], v5, s[28:31], s60 offen offset:2048 sc1
    buffer_load_dwordx4 v[44:47], v5, s[28:31], s60 offen offset:3072 sc1
    buffer_load_dwordx4 v[48:51], v5, s[28:31], s62 offen offset:0 sc1
    buffer_load_dwordx4 v[52:55], v5, s[28:31], s62 offen offset:1024 sc1
    buffer_load_dwordx4 v[56:59], v5, s[28:31], s62 offen offset:2048 sc1
    buffer_load_dwordx4 v[60:63], v5, s[28:31], s62 offen offset:3072 sc1
    s_branch L_qa_chk
L_qa_ok:
    s_mov_b64 exec, -1
    s_waitcnt lgkmcnt(15)
    v_mfma_f32_16x16x32_bf16 v[64:67], a[0:3], v[32:35], 0
    ds_read_b64_tr_b16 a[128:129], v8 offset:0
    ds_read_b64_tr_b16 a[130:131], v8 offset:16896
    ds_read_b64_tr_b16 a[136:137], v8 offset:32
    v_mfma_f32_16x16x32_bf16 v[68:71], a[32:35], v[32:35], 0
    ds_read_b64_tr_b16 a[138:139], v8 offset:16928
    ds_read_b64_tr_b16 a[144:145], v8 offset:64
    v_mfma_f32_16x16x32_bf16 v[72:75], a[64:67], v[32:35], 0
    ds_read_b64_tr_b16 a[146:147], v8 offset:16960
    ds_read_b64_tr_b16 a[152:153], v8 offset:96
    v_mfma_f32_16x16x32_bf16 v[76:79], a[96:99], v[32:35], 0
    ds_read_b64_tr_b16 a[154:155], v8 offset:16992
    ds_read_b64_tr_b16 a[160:161], v8 offset:128
    ds_read_b64_tr_b16 a[162:163], v8 offset:17024
    v_mfma_f32_16x16x32_bf16 v[64:67], a[4:7], v[36:39], v[64:67]
    ds_read_b64_tr_b16 a[168:169], v8 offset:160
    ds_read_b64_tr_b16 a[170:171], v8 offset:17056
    v_mfma_f32_16x16x32_bf16 v[68:71], a[36:39], v[36:39], v[68:71]
    ds_read_b64_tr_b16 a[176:177], v8 offset:192
    ds_read_b64_tr_b16 a[178:179], v8 offset:17088
    v_mfma_f32_16x16x32_bf16 v[72:75], a[68:71], v[36:39], v[72:75]
    ds_read_b64_tr_b16 a[184:185], v8 offset:224
    ds_read_b64_tr_b16 a[186:187], v8 offset:17120
    ds_read_b64_tr_b16 a[192:193], v8 offset:256
    v_mfma_f32_16x16x32_bf16 v[76:79], a[100:103], v[36:39], v[76:79]
    ds_read_b64_tr_b16 a[194:195], v8 offset:17152
    ds_read_b64_tr_b16 a[200:201], v8 offset:288
    v_mfma_f32_16x16x32_bf16 v[64:67], a[8:11], v[40:43], v[64:67]
    ds_read_b64_tr_b16 a[202:203], v8 offset:17184
    ds_read_b64_tr_b16 a[208:209], v8 offset:320
    v_mfma_f32_16x16x32_bf16 v[68:71], a[40:43], v[40:43], v[68:71]
    ds_read_b64_tr_b16 a[210:211], v8 offset:17216
    ds_read_b64_tr_b16 a[216:217], v8 offset:352
    ds_read_b64_tr_b16 a[218:219], v8 offset:17248
    v_mfma_f32_16x16x32_bf16 v[72:75], a[72:75], v[40:43], v[72:75]
    ds_read_b64_tr_b16 a[224:225], v8 offset:384
    ds_read_b64_tr_b16 a[226:227], v8 offset:17280
    v_mfma_f32_16x16x32_bf16 v[76:79], a[104:107], v[40:43], v[76:79]
    ds_read_b64_tr_b16 a[232:233], v8 offset:416
    ds_read_b64_tr_b16 a[234:235], v8 offset:17312
    v_mfma_f32_16x16x32_bf16 v[64:67], a[12:15], v[44:47], v[64:67]
    ds_read_b64_tr_b16 a[240:241], v8 offset:448
    ds_read_b64_tr_b16 a[242:243], v8 offset:17344
    ds_read_b64_tr_b16 a[248:249], v8 offset:480
    v_mfma_f32_16x16x32_bf16 v[68:71], a[44:47], v[44:47], v[68:71]
    ds_read_b64_tr_b16 a[250:251], v8 offset:17376
    ds_read_b64_tr_b16 a[132:133], v8 offset:33792
    v_mfma_f32_16x16x32_bf16 v[72:75], a[76:79], v[44:47], v[72:75]
    ds_read_b64_tr_b16 a[134:135], v8 offset:50688
    ds_read_b64_tr_b16 a[140:141], v8 offset:33824
    v_mfma_f32_16x16x32_bf16 v[76:79], a[108:111], v[44:47], v[76:79]
    ds_read_b64_tr_b16 a[142:143], v8 offset:50720
    ds_read_b64_tr_b16 a[148:149], v8 offset:33856
    ds_read_b64_tr_b16 a[150:151], v8 offset:50752
    v_mfma_f32_16x16x32_bf16 v[64:67], a[16:19], v[48:51], v[64:67]
    ds_read_b64_tr_b16 a[156:157], v8 offset:33888
    ds_read_b64_tr_b16 a[158:159], v8 offset:50784
    s_waitcnt lgkmcnt(15)
    v_mfma_f32_16x16x32_bf16 v[68:71], a[48:51], v[48:51], v[68:71]
    ds_read_b64_tr_b16 a[164:165], v8 offset:33920
    ds_read_b64_tr_b16 a[166:167], v8 offset:50816
    v_mfma_f32_16x16x32_bf16 v[72:75], a[80:83], v[48:51], v[72:75]
    ds_read_b64_tr_b16 a[172:173], v8 offset:33952
    ds_read_b64_tr_b16 a[174:175], v8 offset:50848
    ds_read_b64_tr_b16 a[180:181], v8 offset:33984
    v_mfma_f32_16x16x32_bf16 v[76:79], a[112:115], v[48:51], v[76:79]
    ds_read_b64_tr_b16 a[182:183], v8 offset:50880
    ds_read_b64_tr_b16 a[188:189], v8 offset:34016
    v_mfma_f32_16x16x32_bf16 v[64:67], a[20:23], v[52:55], v[64:67]
    ds_read_b64_tr_b16 a[190:191], v8 offset:50912
    ds_read_b64_tr_b16 a[196:197], v8 offset:34048
    v_mfma_f32_16x16x32_bf16 v[68:71], a[52:55], v[52:55], v[68:71]
    ds_read_b64_tr_b16 a[198:199], v8 offset:50944
    ds_read_b64_tr_b16 a[204:205], v8 offset:34080
    ds_read_b64_tr_b16 a[206:207], v8 offset:50976
    v_mfma_f32_16x16x32_bf16 v[72:75], a[84:87], v[52:55], v[72:75]
    ds_read_b64_tr_b16 a[212:213], v8 offset:34112
    ds_read_b64_tr_b16 a[214:215], v8 offset:51008
    v_mfma_f32_16x16x32_bf16 v[76:79], a[116:119], v[52:55], v[76:79]
    ds_read_b64_tr_b16 a[220:221], v8 offset:34144
    ds_read_b64_tr_b16 a[222:223], v8 offset:51040
    v_mfma_f32_16x16x32_bf16 v[64:67], a[24:27], v[56:59], v[64:67]
    ds_read_b64_tr_b16 a[228:229], v8 offset:34176
    ds_read_b64_tr_b16 a[230:231], v8 offset:51072
    ds_read_b64_tr_b16 a[236:237], v8 offset:34208
    v_mfma_f32_16x16x32_bf16 v[68:71], a[56:59], v[56:59], v[68:71]
    ds_read_b64_tr_b16 a[238:239], v8 offset:51104
    ds_read_b64_tr_b16 a[244:245], v8 offset:34240
    v_mfma_f32_16x16x32_bf16 v[72:75], a[88:91], v[56:59], v[72:75]
    ds_read_b64_tr_b16 a[246:247], v8 offset:51136
    ds_read_b64_tr_b16 a[252:253], v8 offset:34272
    v_mfma_f32_16x16x32_bf16 v[76:79], a[120:123], v[56:59], v[76:79]
    ds_read_b64_tr_b16 a[254:255], v8 offset:51168
    v_mfma_f32_16x16x32_bf16 v[64:67], a[28:31], v[60:63], v[64:67]
    v_mfma_f32_16x16x32_bf16 v[68:71], a[60:63], v[60:63], v[68:71]
    v_mfma_f32_16x16x32_bf16 v[72:75], a[92:95], v[60:63], v[72:75]
    v_mfma_f32_16x16x32_bf16 v[76:79], a[124:127], v[60:63], v[76:79]
    s_nop 4
    ds_write_b128 v11, v[64:67] offset:0
    ds_write_b128 v11, v[68:71] offset:1024
    ds_write_b128 v11, v[72:75] offset:2048
    ds_write_b128 v11, v[76:79] offset:3072
    s_waitcnt lgkmcnt(0)
    s_barrier
    ds_read_b128 v[80:83], v12 offset:0
    ds_read_b128 v[84:87], v12 offset:1024
    ds_read_b128 v[88:91], v12 offset:2048
    ds_read_b128 v[92:95], v12 offset:3072
    s_waitcnt lgkmcnt(3)
    v_add_f32 v64, v64, v80
    v_add_f32 v65, v65, v81
    v_add_f32 v66, v66, v82
    v_add_f32 v67, v67, v83
    v_max3_f32 v104, v64, v65, v66
    v_mov_b32 v105, v67
    s_waitcnt lgkmcnt(2)
    v_add_f32 v68, v68, v84
    v_add_f32 v69, v69, v85
    v_add_f32 v70, v70, v86
    v_add_f32 v71, v71, v87
    v_max3_f32 v104, v104, v68, v69
    v_max3_f32 v105, v105, v70, v71
    s_waitcnt lgkmcnt(1)
    v_add_f32 v72, v72, v88
    v_add_f32 v73, v73, v89
    v_add_f32 v74, v74, v90
    v_add_f32 v75, v75, v91
    v_max3_f32 v104, v104, v72, v73
    v_max3_f32 v105, v105, v74, v75
    s_waitcnt lgkmcnt(0)
    v_add_f32 v76, v76, v92
    v_add_f32 v77, v77, v93
    v_add_f32 v78, v78, v94
    v_add_f32 v79, v79, v95
    v_max3_f32 v104, v104, v76, v77
    v_max3_f32 v105, v105, v78, v79
    v_max_f32 v104, v104, v105
    v_mov_b32 v108, v104
    s_nop 1
    v_permlane32_swap_b32 v104, v108
    v_max_f32 v104, v104, v108
    v_mov_b32 v108, v104
    s_nop 1
    v_permlane16_swap_b32 v104, v108
    v_max_f32 v104, v104, v108
    v_sub_f32 v64, v64, v104
    v_sub_f32 v65, v65, v104
    v_sub_f32 v66, v66, v104
    v_sub_f32 v67, v67, v104
    v_sub_f32 v68, v68, v104
    v_sub_f32 v69, v69, v104
    v_sub_f32 v70, v70, v104
    v_sub_f32 v71, v71, v104
    v_exp_f32 v64, v64
    v_exp_f32 v65, v65
    v_exp_f32 v66, v66
    v_exp_f32 v67, v67
    v_exp_f32 v68, v68
    v_exp_f32 v69, v69
    v_exp_f32 v70, v70
    v_exp_f32 v71, v71
    v_cvt_pk_bf16_f32 v96, v64, v65
    v_cvt_pk_bf16_f32 v97, v66, v67
    v_cvt_pk_bf16_f32 v98, v68, v69
    v_cvt_pk_bf16_f32 v99, v70, v71
    s_nop 1
    v_mfma_f32_16x16x32_bf16 v[128:131], v[96:99], a[128:131], 0
    v_sub_f32 v72, v72, v104
    v_sub_f32 v73, v73, v104
    v_mfma_f32_16x16x32_bf16 v[132:135], v[96:99], a[136:139], 0
    v_sub_f32 v74, v74, v104
    v_sub_f32 v75, v75, v104
    v_mfma_f32_16x16x32_bf16 v[136:139], v[96:99], a[144:147], 0
    v_sub_f32 v76, v76, v104
    v_sub_f32 v77, v77, v104
    v_mfma_f32_16x16x32_bf16 v[140:143], v[96:99], a[152:155], 0
    v_sub_f32 v78, v78, v104
    v_sub_f32 v79, v79, v104
    v_mfma_f32_16x16x32_bf16 v[144:147], v[96:99], a[160:163], 0
    v_exp_f32 v72, v72
    v_mfma_f32_16x16x32_bf16 v[148:151], v[96:99], a[168:171], 0
    v_exp_f32 v73, v73
    v_mfma_f32_16x16x32_bf16 v[152:155], v[96:99], a[176:179], 0
    v_exp_f32 v74, v74
    v_mfma_f32_16x16x32_bf16 v[156:159], v[96:99], a[184:187], 0
    v_exp_f32 v75, v75
    v_mfma_f32_16x16x32_bf16 v[160:163], v[96:99], a[192:195], 0
    v_exp_f32 v76, v76
    v_mfma_f32_16x16x32_bf16 v[164:167], v[96:99], a[200:203], 0
    v_exp_f32 v77, v77
    v_mfma_f32_16x16x32_bf16 v[168:171], v[96:99], a[208:211], 0
    v_exp_f32 v78, v78
    v_mfma_f32_16x16x32_bf16 v[172:175], v[96:99], a[216:219], 0
    v_exp_f32 v79, v79
    v_mfma_f32_16x16x32_bf16 v[176:179], v[96:99], a[224:227], 0
    v_cvt_pk_bf16_f32 v100, v72, v73
    v_cvt_pk_bf16_f32 v101, v74, v75
    v_mfma_f32_16x16x32_bf16 v[180:183], v[96:99], a[232:235], 0
    v_cvt_pk_bf16_f32 v102, v76, v77
    v_cvt_pk_bf16_f32 v103, v78, v79
    v_mfma_f32_16x16x32_bf16 v[184:187], v[96:99], a[240:243], 0
    v_mfma_f32_16x16x32_bf16 v[188:191], v[96:99], a[248:251], 0
    v_mfma_f32_16x16x32_bf16 v[128:131], v[100:103], a[132:135], v[128:131]
    v_add_f32 v64, v64, v72
    v_add_f32 v65, v65, v73
    v_mfma_f32_16x16x32_bf16 v[132:135], v[100:103], a[140:143], v[132:135]
    v_add_f32 v66, v66, v74
    v_add_f32 v67, v67, v75
    v_mfma_f32_16x16x32_bf16 v[136:139], v[100:103], a[148:151], v[136:139]
    v_add_f32 v68, v68, v76
    v_add_f32 v69, v69, v77
    v_mfma_f32_16x16x32_bf16 v[140:143], v[100:103], a[156:159], v[140:143]
    v_add_f32 v70, v70, v78
    v_add_f32 v71, v71, v79
    v_mfma_f32_16x16x32_bf16 v[144:147], v[100:103], a[164:167], v[144:147]
    v_add_f32 v64, v64, v68
    v_add_f32 v65, v65, v69
    v_mfma_f32_16x16x32_bf16 v[148:151], v[100:103], a[172:175], v[148:151]
    v_add_f32 v66, v66, v70
    v_add_f32 v67, v67, v71
    v_mfma_f32_16x16x32_bf16 v[152:155], v[100:103], a[180:183], v[152:155]
    v_add_f32 v64, v64, v65
    v_add_f32 v66, v66, v67
    v_mfma_f32_16x16x32_bf16 v[156:159], v[100:103], a[188:191], v[156:159]
    v_add_f32 v105, v64, v66
    v_mov_b32 v108, v105
    v_mfma_f32_16x16x32_bf16 v[160:163], v[100:103], a[196:199], v[160:163]
    v_mfma_f32_16x16x32_bf16 v[164:167], v[100:103], a[204:207], v[164:167]
    v_cvt_pk_bf16_f32 v192, v128, v132
    v_cvt_pk_bf16_f32 v193, v136, v140
    v_mfma_f32_16x16x32_bf16 v[168:171], v[100:103], a[212:215], v[168:171]
    v_cvt_pk_bf16_f32 v194, v144, v148
    v_cvt_pk_bf16_f32 v195, v152, v156
    v_mfma_f32_16x16x32_bf16 v[172:175], v[100:103], a[220:223], v[172:175]
    buffer_store_dwordx4 v[192:195], v13, s[28:31], s64 offen offset:0 sc1
    v_cvt_pk_bf16_f32 v196, v129, v133
    v_mfma_f32_16x16x32_bf16 v[176:179], v[100:103], a[228:231], v[176:179]
    v_cvt_pk_bf16_f32 v197, v137, v141
    v_cvt_pk_bf16_f32 v198, v145, v149
    v_mfma_f32_16x16x32_bf16 v[180:183], v[100:103], a[236:239], v[180:183]
    v_cvt_pk_bf16_f32 v199, v153, v157
    buffer_store_dwordx4 v[196:199], v13, s[28:31], s65 offen offset:0 sc1
    v_mfma_f32_16x16x32_bf16 v[184:187], v[100:103], a[244:247], v[184:187]
    v_cvt_pk_bf16_f32 v200, v130, v134
    v_cvt_pk_bf16_f32 v201, v138, v142
    v_mfma_f32_16x16x32_bf16 v[188:191], v[100:103], a[252:255], v[188:191]
    v_cvt_pk_bf16_f32 v202, v146, v150
    v_cvt_pk_bf16_f32 v203, v154, v158
    buffer_store_dwordx4 v[200:203], v13, s[28:31], s66 offen offset:0 sc1
    v_cvt_pk_bf16_f32 v204, v131, v135
    v_cvt_pk_bf16_f32 v205, v139, v143
    v_cvt_pk_bf16_f32 v206, v147, v151
    v_cvt_pk_bf16_f32 v207, v155, v159
    buffer_store_dwordx4 v[204:207], v13, s[28:31], s67 offen offset:0 sc1
    v_cvt_pk_bf16_f32 v208, v160, v164
    v_cvt_pk_bf16_f32 v209, v168, v172
    v_cvt_pk_bf16_f32 v210, v176, v180
    v_cvt_pk_bf16_f32 v211, v184, v188
    buffer_store_dwordx4 v[208:211], v13, s[28:31], s64 offen offset:256 sc1
    v_cvt_pk_bf16_f32 v212, v161, v165
    v_cvt_pk_bf16_f32 v213, v169, v173
    v_cvt_pk_bf16_f32 v214, v177, v181
    v_cvt_pk_bf16_f32 v215, v185, v189
    buffer_store_dwordx4 v[212:215], v13, s[28:31], s65 offen offset:256 sc1
    v_cvt_pk_bf16_f32 v216, v162, v166
    v_cvt_pk_bf16_f32 v217, v170, v174
    v_cvt_pk_bf16_f32 v218, v178, v182
    v_cvt_pk_bf16_f32 v219, v186, v190
    buffer_store_dwordx4 v[216:219], v13, s[28:31], s66 offen offset:256 sc1
    v_cvt_pk_bf16_f32 v220, v163, v167
    v_cvt_pk_bf16_f32 v221, v171, v175
    v_cvt_pk_bf16_f32 v222, v179, v183
    v_cvt_pk_bf16_f32 v223, v187, v191
    buffer_store_dwordx4 v[220:223], v13, s[28:31], s67 offen offset:256 sc1
    v_permlane32_swap_b32 v105, v108
    v_add_f32 v105, v105, v108
    v_mov_b32 v108, v105
    s_nop 1
    v_permlane16_swap_b32 v105, v108
    v_add_f32 v105, v105, v108
    s_waitcnt vmcnt(0)
    s_barrier
    s_cmp_lg_u32 s48, 0
    s_cbranch_scc1 L_b_done
    s_mov_b32 exec_lo, 0xffff
    s_mov_b32 exec_hi, 0x0
    buffer_store_dwordx4 v[104:107], v14, s[28:31], s68 offen sc1
    s_mov_b64 exec, -1
L_b_done:
    s_cmp_lg_u32 s3, 0
    s_cbranch_scc1 L_fin
    s_cmp_ge_u32 s46, 20
    s_cbranch_scc1 L_fin
    v_lshrrev_b32 v7, 3, v0
    v_mul_u32_u24 v7, 2560, v7
    v_and_b32 v8, 7, v0
    v_lshl_add_u32 v7, v8, 4, v7
    s_mul_i32 s54, s4, 163840
    s_lshl_b32 s55, s46, 7
    s_add_u32 s54, s54, s55
    s_add_u32 s64, s54, 98304
    s_add_u32 s65, s64, 20480
    s_add_u32 s66, s65, 20480
    s_add_u32 s67, s66, 20480
    s_add_u32 s68, s67, 20480
    s_add_u32 s69, s68, 20480
    s_add_u32 s70, s69, 20480
    s_add_u32 s71, s70, 20480
    s_mul_i32 s54, s4, 1280
    s_lshl_b32 s55, s46, 6
    s_add_u32 s54, s54, s55
    v_lshlrev_b32 v9, 3, v0
    s_mov_b32 s55, 0
L_d_poll:
    buffer_load_dwordx4 v[32:35], v7, s[28:31], s64 offen sc1
    buffer_load_dwordx4 v[36:39], v7, s[28:31], s65 offen sc1
    buffer_load_dwordx4 v[40:43], v7, s[28:31], s66 offen sc1
    buffer_load_dwordx4 v[44:47], v7, s[28:31], s67 offen sc1
    buffer_load_dwordx4 v[48:51], v7, s[28:31], s68 offen sc1
    buffer_load_dwordx4 v[52:55], v7, s[28:31], s69 offen sc1
    buffer_load_dwordx4 v[56:59], v7, s[28:31], s70 offen sc1
    buffer_load_dwordx4 v[60:63], v7, s[28:31], s71 offen sc1
    s_add_u32 s55, s55, 1
    s_waitcnt vmcnt(0)
    v_max3_u32 v10, v32, v33, v34
    v_max3_u32 v108, v35, v36, v37
    v_max3_u32 v10, v10, v38, v39
    v_max3_u32 v108, v108, v40, v41
    v_max3_u32 v10, v10, v42, v43
    v_max3_u32 v108, v108, v44, v45
    v_max3_u32 v10, v10, v46, v47
    v_max3_u32 v108, v108, v48, v49
    v_max3_u32 v10, v10, v50, v51
    v_max3_u32 v108, v108, v52, v53
    v_max3_u32 v10, v10, v54, v55
    v_max3_u32 v108, v108, v56, v57
    v_max3_u32 v10, v10, v58, v59
    v_max3_u32 v108, v108, v60, v61
    v_max3_u32 v10, v10, v62, v63
    v_max_u32 v10, v10, v108
    v_cmp_eq_u32 vcc, -1, v10
    s_cmp_ge_u32 s55, 200000
    s_cbranch_scc1 L_d_ok
    s_cbranch_vccnz L_d_poll
L_d_ok:
    v_add_f32 v32, v32, v48
    v_add_f32 v33, v33, v49
    v_add_f32 v34, v34, v50
    v_add_f32 v35, v35, v51
    v_add_f32 v36, v36, v52
    v_add_f32 v37, v37, v53
    v_add_f32 v38, v38, v54
    v_add_f32 v39, v39, v55
    v_add_f32 v40, v40, v56
    v_add_f32 v41, v41, v57
    v_add_f32 v42, v42, v58
    v_add_f32 v43, v43, v59
    v_add_f32 v44, v44, v60
    v_add_f32 v45, v45, v61
    v_add_f32 v46, v46, v62
    v_add_f32 v47, v47, v63
    v_add_f32 v32, v32, v40
    v_add_f32 v33, v33, v41
    v_add_f32 v34, v34, v42
    v_add_f32 v35, v35, v43
    v_add_f32 v36, v36, v44
    v_add_f32 v37, v37, v45
    v_add_f32 v38, v38, v46
    v_add_f32 v39, v39, v47
    v_add_f32 v32, v32, v36
    v_add_f32 v33, v33, v37
    v_add_f32 v34, v34, v38
    v_add_f32 v35, v35, v39
    v_add_f32_dpp v36, v32, v32 row_ror:8 row_mask:0xf bank_mask:0xf
    v_add_f32_dpp v37, v33, v33 row_ror:8 row_mask:0xf bank_mask:0xf
    v_add_f32_dpp v38, v34, v34 row_ror:8 row_mask:0xf bank_mask:0xf
    v_add_f32_dpp v39, v35, v35 row_ror:8 row_mask:0xf bank_mask:0xf
    v_mov_b32 v40, v36
    v_mov_b32 v41, v37
    v_mov_b32 v42, v38
    v_mov_b32 v43, v39
    v_permlane16_swap_b32 v36, v40
    v_permlane16_swap_b32 v37, v41
    v_permlane16_swap_b32 v38, v42
    v_permlane16_swap_b32 v39, v43
    v_add_f32 v36, v36, v40
    v_add_f32 v37, v37, v41
    v_add_f32 v38, v38, v42
    v_add_f32 v39, v39, v43
    v_mov_b32 v40, v36
    v_mov_b32 v41, v37
    v_mov_b32 v42, v38
    v_mov_b32 v43, v39
    v_permlane32_swap_b32 v36, v40
    v_permlane32_swap_b32 v37, v41
    v_permlane32_swap_b32 v38, v42
    v_permlane32_swap_b32 v39, v43
    v_add_f32 v36, v36, v40
    v_add_f32 v37, v37, v41
    v_add_f32 v38, v38, v42
    v_add_f32 v39, v39, v43
    v_cvt_pk_bf16_f32 v36, v36, v37
    v_cvt_pk_bf16_f32 v37, v38, v39
    s_mov_b32 exec_lo, 0xff
    s_mov_b32 exec_hi, 0x0
    buffer_store_dwordx2 v[36:37], v9, s[32:35], s54 offen
    s_cmp_lg_u32 s46, 0
    s_cbranch_scc1 L_noep
    s_mov_b64 exec, 1
    buffer_store_dwordx2 v[106:107], v9, s[28:31], s56 offen sc1
L_noep:
    s_mov_b64 exec, -1
    s_branch L_fin
L_roleC:
    s_and_b32 s54, s3, 1
    s_lshl_b32 s54, s54, 3
    v_lshl_add_u32 v7, v2, 1, s54
    v_xor_b32 v7, v7, v1
    v_lshlrev_b32 v7, 4, v7
    v_mul_u32_u24 v8, 1280, v2
    v_add_u32 v7, v7, v8
    s_lshl_b32 s54, s5, 7
    s_lshl_b32 s55, s6, 6
    s_add_u32 s54, s54, s55
    s_lshl_b32 s55, s3, 2
    s_add_u32 s54, s54, s55
    s_mul_i32 s47, s54, 1280
    s_mul_i32 s46, s3, 5120
    s_add_u32 s46, s46, 72960
    v_lshrrev_b32 v8, 2, v1
    v_and_b32 v10, 3, v0
    v_and_b32 v16, 1, v2
    v_and_b32 v17, 1, v10
    v_lshrrev_b32 v18, 1, v10
    v_lshlrev_b32 v19, 1, v8
    v_lshrrev_b32 v20, 1, v2
    v_lshl_add_u32 v20, v16, 6, v20
    v_lshl_add_u32 v20, v8, 4, v20
    s_lshl_b32 s54, s3, 14
    s_add_u32 s54, s54, 5376
    v_lshlrev_b32 v20, 7, v20
    v_lshl_add_u32 v20, v17, 3, v20
    v_add_u32 v20, s54, v20
    v_add_u32 v21, 0, v18
    v_xor_b32 v21, v21, v19
    v_lshl_add_u32 v24, v21, 4, v20
    v_add_u32 v21, 2, v18
    v_xor_b32 v21, v21, v19
    v_lshl_add_u32 v25, v21, 4, v20
    v_add_u32 v21, 4, v18
    v_xor_b32 v21, v21, v19
    v_lshl_add_u32 v26, v21, 4, v20
    v_add_u32 v21, 6, v18
    v_xor_b32 v21, v21, v19
    v_lshl_add_u32 v27, v21, 4, v20
    v_lshlrev_b32 v13, 3, v16
    v_lshl_add_u32 v13, v8, 1, v13
    s_lshl_b32 s54, s3, 2
    v_add_u32 v14, s54, v18
    v_xor_b32 v21, v14, v13
    v_add_u32 v14, 2, v14
    v_xor_b32 v14, v14, v13
    v_mul_u32_u24 v22, 5120, v2
    v_lshl_add_u32 v22, v8, 8, v22
    v_lshl_add_u32 v22, v17, 3, v22
    v_add_u32 v22, 72960, v22
    v_lshl_add_u32 v12, v21, 4, v22
    v_lshl_add_u32 v13, v14, 4, v22
    v_add_u32 v14, 40960, v12
    v_add_u32 v11, 40960, v13
    v_lshrrev_b32 v23, 2, v0
    v_mul_u32_u24 v23, 1056, v23
    v_lshl_add_u32 v23, v10, 3, v23
    s_lshl_b32 s54, s3, 8
    s_add_u32 s54, s54, 5376
    v_add_u32 v23, s54, v23
    v_and_b32 v28, 32, v0
    v_lshl_add_u32 v28, v8, 3, v28
    v_lshl_add_u32 v28, v16, 2, v28
    v_add_u32 v28, v28, v10
    s_lshl_b32 s54, s3, 7
    v_lshl_add_u32 v28, v28, 1, s54
    v_lshl_add_u32 v29, v2, 4, s54
    v_lshlrev_b32 v30, 4, v0
    s_lshl_b32 s55, s3, 2
    v_add_u32 v31, s55, v30
    s_lshl_b32 s55, s3, 7
    s_add_u32 s62, s62, s55
    v_lshrrev_b32 v19, 5, v0
    v_lshlrev_b32 v19, 9, v19
    v_and_b32 v20, 31, v0
    v_lshl_add_u32 v19, v20, 2, v19
    s_waitcnt vmcnt(2)
    s_mov_b32 m0, s40
    s_add_u32 s40, s40, s42
    buffer_load_dwordx4 v142, s[20:23], s41 offen nt lds
    s_add_u32 s41, s41, s43
    s_waitcnt vmcnt(2)
    s_mov_b32 m0, s40
    s_add_u32 s40, s40, s42
    buffer_load_dwordx4 v142, s[20:23], s41 offen nt lds
    s_add_u32 s41, s41, s43
    s_waitcnt vmcnt(2)
    s_mov_b32 m0, s40
    s_add_u32 s40, s40, s42
    buffer_load_dwordx4 v143, s[20:23], s41 offen nt lds
    s_add_u32 s41, s41, s43
    s_waitcnt vmcnt(2)
    s_mov_b32 m0, s40
    s_add_u32 s40, s40, s42
    buffer_load_dwordx4 v143, s[20:23], s41 offen nt lds
    s_add_u32 s41, s41, s43
    s_mov_b32 m0, s40
    s_add_u32 s40, s40, s42
    buffer_load_dwordx4 v140, s[20:23], s41 offen nt lds
    s_add_u32 s41, s41, s43
    s_mov_b32 m0, s40
    s_add_u32 s40, s40, s42
    buffer_load_dwordx4 v140, s[20:23], s41 offen nt lds
    s_add_u32 s41, s41, s43
    s_mov_b32 m0, s40
    s_add_u32 s40, s40, s42
    buffer_load_dwordx4 v141, s[20:23], s41 offen nt lds
    s_add_u32 s41, s41, s43
    s_mov_b32 m0, s40
    s_add_u32 s40, s40, s42
    buffer_load_dwordx4 v141, s[20:23], s41 offen nt lds
    s_add_u32 s41, s41, s43
    s_mov_b32 m0, s40
    s_add_u32 s40, s40, s42
    buffer_load_dwordx4 v142, s[20:23], s41 offen nt lds
    s_add_u32 s41, s41, s43
    s_mov_b32 m0, s40
    s_add_u32 s40, s40, s42
    buffer_load_dwordx4 v142, s[20:23], s41 offen nt lds
    s_add_u32 s41, s41, s43
    s_mov_b32 m0, s40
    s_add_u32 s40, s40, s42
    buffer_load_dwordx4 v143, s[20:23], s41 offen nt lds
    s_add_u32 s41, s41, s43
    s_waitcnt vmcnt(9)
    s_mov_b32 m0, s40
    s_add_u32 s40, s40, s42
    buffer_load_dwordx4 v143, s[20:23], s41 offen nt lds
    s_add_u32 s41, s41, s43
    s_barrier
    s_mov_b32 m0, s46
    s_add_u32 s46, s46, 1024
    buffer_load_dwordx4 v7, s[24:27], s47 offen nt lds
    s_add_u32 s47, s47, 256
    s_mov_b32 m0, s46
    s_add_u32 s46, s46, 1024
    buffer_load_dwordx4 v7, s[24:27], s47 offen nt lds
    s_add_u32 s47, s47, 256
    s_mov_b32 m0, s46
    s_add_u32 s46, s46, 1024
    buffer_load_dwordx4 v7, s[24:27], s47 offen nt lds
    s_add_u32 s47, s47, 256
    s_mov_b32 m0, s46
    s_add_u32 s46, s46, 1024
    buffer_load_dwordx4 v7, s[24:27], s47 offen nt lds
    s_add_u32 s47, s47, 256
    s_waitcnt vmcnt(13)
    s_mov_b32 m0, s46
    s_add_u32 s46, s46, 16384
    buffer_load_dwordx4 v7, s[24:27], s47 offen nt lds
    s_add_u32 s47, s47, 19456
    s_waitcnt vmcnt(13)
    s_mov_b32 m0, s46
    s_add_u32 s46, s46, 1024
    buffer_load_dwordx4 v7, s[24:27], s47 offen nt lds
    s_add_u32 s47, s47, 256
    s_waitcnt vmcnt(13)
    s_mov_b32 m0, s46
    s_add_u32 s46, s46, 1024
    buffer_load_dwordx4 v7, s[24:27], s47 offen nt lds
    s_add_u32 s47, s47, 256
    s_waitcnt vmcnt(13)
    s_mov_b32 m0, s46
    s_add_u32 s46, s46, 1024
    buffer_load_dwordx4 v7, s[24:27], s47 offen nt lds
    s_add_u32 s47, s47, 256
    s_waitcnt vmcnt(13)
    s_mov_b32 m0, s46
    s_add_u32 s46, s46, 1024
    buffer_load_dwordx4 v7, s[24:27], s47 offen nt lds
    s_add_u32 s47, s47, 256
    s_waitcnt vmcnt(13)
    s_mov_b32 m0, s46
    s_add_u32 s46, s46, 16384
    buffer_load_dwordx4 v7, s[24:27], s47 offen nt lds
    s_add_u32 s47, s47, 19456
    s_waitcnt vmcnt(13)
    s_mov_b32 m0, s46
    s_add_u32 s46, s46, 1024
    buffer_load_dwordx4 v7, s[24:27], s47 offen nt lds
    s_add_u32 s47, s47, 256
    s_waitcnt vmcnt(13)
    s_mov_b32 m0, s46
    s_add_u32 s46, s46, 1024
    buffer_load_dwordx4 v7, s[24:27], s47 offen nt lds
    s_add_u32 s47, s47, 256
    s_waitcnt vmcnt(13)
    s_mov_b32 m0, s46
    s_add_u32 s46, s46, 1024
    buffer_load_dwordx4 v7, s[24:27], s47 offen nt lds
    s_add_u32 s47, s47, 256
    s_waitcnt vmcnt(13)
    s_mov_b32 m0, s46
    s_add_u32 s46, s46, 1024
    buffer_load_dwordx4 v7, s[24:27], s47 offen nt lds
    s_add_u32 s47, s47, 256
    ds_read_b64_tr_b16 a[0:1], v24 offset:0
    ds_read_b64_tr_b16 a[2:3], v24 offset:256
    ds_read_b64_tr_b16 a[4:5], v24 offset:512
    ds_read_b64_tr_b16 a[6:7], v24 offset:768
    ds_read_b64_tr_b16 a[8:9], v24 offset:1024
    ds_read_b64_tr_b16 a[10:11], v24 offset:1280
    ds_read_b64_tr_b16 a[12:13], v24 offset:1536
    ds_read_b64_tr_b16 a[14:15], v24 offset:1792
    ds_read_b64_tr_b16 a[16:17], v25 offset:0
    ds_read_b64_tr_b16 a[18:19], v25 offset:256
    ds_read_b64_tr_b16 a[20:21], v25 offset:512
    ds_read_b64_tr_b16 a[22:23], v25 offset:768
    ds_read_b64_tr_b16 a[24:25], v25 offset:1024
    ds_read_b64_tr_b16 a[26:27], v25 offset:1280
    ds_read_b64_tr_b16 a[28:29], v25 offset:1536
    ds_read_b64_tr_b16 a[30:31], v25 offset:1792
    ds_read_b64_tr_b16 a[32:33], v26 offset:0
    ds_read_b64_tr_b16 a[34:35], v26 offset:256
    ds_read_b64_tr_b16 a[36:37], v26 offset:512
    ds_read_b64_tr_b16 a[38:39], v26 offset:768
    ds_read_b64_tr_b16 a[40:41], v26 offset:1024
    ds_read_b64_tr_b16 a[42:43], v26 offset:1280
    ds_read_b64_tr_b16 a[44:45], v26 offset:1536
    ds_read_b64_tr_b16 a[46:47], v26 offset:1792
    ds_read_b64_tr_b16 a[48:49], v27 offset:0
    ds_read_b64_tr_b16 a[50:51], v27 offset:256
    ds_read_b64_tr_b16 a[52:53], v27 offset:512
    ds_read_b64_tr_b16 a[54:55], v27 offset:768
    ds_read_b64_tr_b16 a[56:57], v27 offset:1024
    ds_read_b64_tr_b16 a[58:59], v27 offset:1280
    ds_read_b64_tr_b16 a[60:61], v27 offset:1536
    ds_read_b64_tr_b16 a[62:63], v27 offset:1792
    s_waitcnt vmcnt(13)
    s_mov_b32 m0, s46
    s_add_u32 s46, s46, 16384
    buffer_load_dwordx4 v7, s[24:27], s47 offen nt lds
    s_add_u32 s47, s47, 19456
    s_waitcnt vmcnt(13)
    s_mov_b32 m0, s46
    s_add_u32 s46, s46, 1024
    buffer_load_dwordx4 v7, s[24:27], s47 offen nt lds
    s_add_u32 s47, s47, 256
    s_waitcnt vmcnt(13)
    s_mov_b32 m0, s46
    s_add_u32 s46, s46, 1024
    buffer_load_dwordx4 v7, s[24:27], s47 offen nt lds
    s_add_u32 s47, s47, 256
    s_waitcnt vmcnt(13)
    s_mov_b32 m0, s46
    s_add_u32 s46, s46, 1024
    buffer_load_dwordx4 v7, s[24:27], s47 offen nt lds
    s_add_u32 s47, s47, 256
    s_waitcnt vmcnt(13)
    s_mov_b32 m0, s46
    s_add_u32 s46, s46, 1024
    buffer_load_dwordx4 v7, s[24:27], s47 offen nt lds
    s_add_u32 s47, s47, 256
    s_waitcnt vmcnt(13)
    s_mov_b32 m0, s46
    s_add_u32 s46, s46, 16384
    buffer_load_dwordx4 v7, s[24:27], s47 offen nt lds
    s_add_u32 s47, s47, 19456
    s_waitcnt lgkmcnt(0)
    s_barrier
    s_lshl_b32 s54, s61, 6
    s_lshl_b32 s55, s3, 4
    s_add_u32 s54, s54, s55
    s_lshl_b32 s17, s54, 10
    s_add_u32 s17, s17, 1048576
    s_mul_i32 s18, s3, 16896
    s_add_u32 s18, s18, 5376
    s_mov_b32 s13, s62
    s_mov_b32 s16, 0
    s_lshl_b32 s12, s54, 4
    s_add_u32 s12, s12, 5242880
    s_mov_b32 s8, s52
    s_mov_b32 s9, s53
    s_lshl_b32 s54, s3, 7
    v_lshlrev_b32 v21, 3, v0
    v_add_u32 v22, s54, v21
L_st:
    s_load_dwordx16 s[36:51], s[28:29], s12 offset:0 glc
    s_load_dwordx16 s[52:67], s[28:29], s12 offset:64 glc
    s_load_dwordx16 s[68:83], s[28:29], s12 offset:128 glc
    s_load_dwordx16 s[84:99], s[28:29], s12 offset:192 glc
    s_add_u32 s16, s16, 1
    s_waitcnt lgkmcnt(0)
    s_xor_b64 s[38:39], s[38:39], s[8:9]
    s_xor_b64 s[42:43], s[42:43], s[8:9]
    s_or_b64 s[38:39], s[38:39], s[42:43]
    s_xor_b64 s[46:47], s[46:47], s[8:9]
    s_or_b64 s[38:39], s[38:39], s[46:47]
    s_xor_b64 s[50:51], s[50:51], s[8:9]
    s_or_b64 s[38:39], s[38:39], s[50:51]
    s_xor_b64 s[54:55], s[54:55], s[8:9]
    s_or_b64 s[38:39], s[38:39], s[54:55]
    s_xor_b64 s[58:59], s[58:59], s[8:9]
    s_or_b64 s[38:39], s[38:39], s[58:59]
    s_xor_b64 s[62:63], s[62:63], s[8:9]
    s_or_b64 s[38:39], s[38:39], s[62:63]
    s_xor_b64 s[66:67], s[66:67], s[8:9]
    s_or_b64 s[38:39], s[38:39], s[66:67]
    s_xor_b64 s[70:71], s[70:71], s[8:9]
    s_or_b64 s[38:39], s[38:39], s[70:71]
    s_xor_b64 s[74:75], s[74:75], s[8:9]
    s_or_b64 s[38:39], s[38:39], s[74:75]
    s_xor_b64 s[78:79], s[78:79], s[8:9]
    s_or_b64 s[38:39], s[38:39], s[78:79]
    s_xor_b64 s[82:83], s[82:83], s[8:9]
    s_or_b64 s[38:39], s[38:39], s[82:83]
    s_xor_b64 s[86:87], s[86:87], s[8:9]
    s_or_b64 s[38:39], s[38:39], s[86:87]
    s_xor_b64 s[90:91], s[90:91], s[8:9]
    s_or_b64 s[38:39], s[38:39], s[90:91]
    s_xor_b64 s[94:95], s[94:95], s[8:9]
    s_or_b64 s[38:39], s[38:39], s[94:95]
    s_xor_b64 s[98:99], s[98:99], s[8:9]
    s_or_b64 s[38:39], s[38:39], s[98:99]
    s_cmp_ge_u32 s16, 200000
    s_cbranch_scc1 L_st_ok
    s_cmp_lg_u64 s[38:39], 0
    s_cbranch_scc1 L_st
L_st_ok:
    s_mov_b32 m0, s18
    s_add_u32 s18, s18, 1056
    buffer_load_dwordx4 v6, s[28:31], s17 offen sc1 lds
    s_add_u32 s17, s17, 1024
    s_mov_b32 m0, s18
    s_add_u32 s18, s18, 1056
    buffer_load_dwordx4 v6, s[28:31], s17 offen sc1 lds
    s_add_u32 s17, s17, 1024
    s_mov_b32 m0, s18
    s_add_u32 s18, s18, 1056
    buffer_load_dwordx4 v6, s[28:31], s17 offen sc1 lds
    s_add_u32 s17, s17, 1024
    s_mov_b32 m0, s18
    s_add_u32 s18, s18, 1056
    buffer_load_dwordx4 v6, s[28:31], s17 offen sc1 lds
    s_add_u32 s17, s17, 1024
    s_mov_b32 m0, s18
    s_add_u32 s18, s18, 1056
    buffer_load_dwordx4 v6, s[28:31], s17 offen sc1 lds
    s_add_u32 s17, s17, 1024
    s_mov_b32 m0, s18
    s_add_u32 s18, s18, 1056
    buffer_load_dwordx4 v6, s[28:31], s17 offen sc1 lds
    s_add_u32 s17, s17, 1024
    s_mov_b32 m0, s18
    s_add_u32 s18, s18, 1056
    buffer_load_dwordx4 v6, s[28:31], s17 offen sc1 lds
    s_add_u32 s17, s17, 1024
    s_mov_b32 m0, s18
    s_add_u32 s18, s18, 1056
    buffer_load_dwordx4 v6, s[28:31], s17 offen sc1 lds
    s_add_u32 s17, s17, 1024
    s_mov_b32 m0, s18
    s_add_u32 s18, s18, 1056
    buffer_load_dwordx4 v6, s[28:31], s17 offen sc1 lds
    s_add_u32 s17, s17, 1024
    s_mov_b32 m0, s18
    s_add_u32 s18, s18, 1056
    buffer_load_dwordx4 v6, s[28:31], s17 offen sc1 lds
    s_add_u32 s17, s17, 1024
    s_mov_b32 m0, s18
    s_add_u32 s18, s18, 1056
    buffer_load_dwordx4 v6, s[28:31], s17 offen sc1 lds
    s_add_u32 s17, s17, 1024
    s_mov_b32 m0, s18
    s_add_u32 s18, s18, 1056
    buffer_load_dwordx4 v6, s[28:31], s17 offen sc1 lds
    s_add_u32 s17, s17, 1024
    s_mov_b32 m0, s18
    s_add_u32 s18, s18, 1056
    buffer_load_dwordx4 v6, s[28:31], s17 offen sc1 lds
    s_add_u32 s17, s17, 1024
    s_mov_b32 m0, s18
    s_add_u32 s18, s18, 1056
    buffer_load_dwordx4 v6, s[28:31], s17 offen sc1 lds
    s_add_u32 s17, s17, 1024
    s_mov_b32 m0, s18
    s_add_u32 s18, s18, 1056
    buffer_load_dwordx4 v6, s[28:31], s17 offen sc1 lds
    s_add_u32 s17, s17, 1024
    s_mov_b32 m0, s18
    s_add_u32 s18, s18, 1056
    buffer_load_dwordx4 v6, s[28:31], s17 offen sc1 lds
    s_add_u32 s17, s17, 1024
    v_writelane_b32 v120, s36, 0
    v_writelane_b32 v121, s37, 0
    v_writelane_b32 v120, s40, 1
    v_writelane_b32 v121, s41, 1
    v_writelane_b32 v120, s44, 2
    v_writelane_b32 v121, s45, 2
    v_writelane_b32 v120, s48, 3
    v_writelane_b32 v121, s49, 3
    v_writelane_b32 v120, s52, 4
    v_writelane_b32 v121, s53, 4
    v_writelane_b32 v120, s56, 5
    v_writelane_b32 v121, s57, 5
    v_writelane_b32 v120, s60, 6
    v_writelane_b32 v121, s61, 6
    v_writelane_b32 v120, s64, 7
    v_writelane_b32 v121, s65, 7
    v_writelane_b32 v120, s68, 8
    v_writelane_b32 v121, s69, 8
    v_writelane_b32 v120, s72, 9
    v_writelane_b32 v121, s73, 9
    v_writelane_b32 v120, s76, 10
    v_writelane_b32 v121, s77, 10
    v_writelane_b32 v120, s80, 11
    v_writelane_b32 v121, s81, 11
    v_writelane_b32 v120, s84, 12
    v_writelane_b32 v121, s85, 12
    v_writelane_b32 v120, s88, 13
    v_writelane_b32 v121, s89, 13
    v_writelane_b32 v120, s92, 14
    v_writelane_b32 v121, s93, 14
    v_writelane_b32 v120, s96, 15
    v_writelane_b32 v121, s97, 15
    s_mov_b32 exec_lo, 0xffff
    s_mov_b32 exec_hi, 0x0
    ds_write_b64 v22, v[120:121] offset:2816
    s_mov_b64 exec, -1
    v_cmp_eq_u32 s[56:57], 1, v16
    v_cmp_lt_u32 s[58:59], 31, v0
    s_waitcnt lgkmcnt(0)
    s_barrier
    ds_read_b64 v[120:121], v21 offset:2816
    s_waitcnt lgkmcnt(0)
    v_mov_b32 v122, v120
    s_nop 1
    v_max_f32_dpp v122, v122, v122 row_ror:8 row_mask:0xf bank_mask:0xf
    s_nop 1
    v_max_f32_dpp v122, v122, v122 row_ror:4 row_mask:0xf bank_mask:0xf
    s_nop 1
    v_max_f32_dpp v122, v122, v122 row_ror:2 row_mask:0xf bank_mask:0xf
    s_nop 1
    v_max_f32_dpp v122, v122, v122 row_ror:1 row_mask:0xf bank_mask:0xf
    v_mov_b32 v123, v122
    s_nop 1
    v_permlane32_swap_b32 v122, v123
    v_max_f32 v122, v122, v123
    v_mov_b32 v123, v122
    s_nop 1
    v_permlane16_swap_b32 v122, v123
    v_max_f32 v122, v122, v123
    v_sub_f32 v120, v120, v122
    v_exp_f32 v120, v120
    s_nop 0
    v_mul_f32 v121, v120, v121
    s_nop 1
    v_add_f32_dpp v121, v121, v121 row_ror:8 row_mask:0xf bank_mask:0xf
    s_nop 1
    v_add_f32_dpp v121, v121, v121 row_ror:4 row_mask:0xf bank_mask:0xf
    s_nop 1
    v_add_f32_dpp v121, v121, v121 row_ror:2 row_mask:0xf bank_mask:0xf
    s_nop 1
    v_add_f32_dpp v121, v121, v121 row_ror:1 row_mask:0xf bank_mask:0xf
    v_mov_b32 v123, v121
    s_nop 1
    v_permlane32_swap_b32 v121, v123
    v_add_f32 v121, v121, v123
    v_mov_b32 v123, v121
    s_nop 1
    v_permlane16_swap_b32 v121, v123
    v_add_f32 v121, v121, v123
    v_rcp_f32 v121, v121
    s_nop 0
    v_mul_f32 v120, v120, v121
    v_cvt_pk_bf16_f32 v120, v120, v120
    ds_write_b16 v28, v120 offset:3328
    s_waitcnt lgkmcnt(0)
    ds_read_b128 v[96:99], v29 offset:3328
    ds_read_b128 v[100:103], v29 offset:3392
    s_waitcnt vmcnt(16)
    s_barrier
    ds_read_b64_tr_b16 a[64:65], v12 offset:0
    ds_read_b64_tr_b16 a[66:67], v12 offset:20480
    ds_read_b64_tr_b16 a[72:73], v13 offset:0
    ds_read_b64_tr_b16 a[74:75], v13 offset:20480
    ds_read_b64_tr_b16 a[80:81], v12 offset:1024
    ds_read_b64_tr_b16 a[82:83], v12 offset:21504
    ds_read_b64_tr_b16 a[88:89], v13 offset:1024
    ds_read_b64_tr_b16 a[90:91], v13 offset:21504
    ds_read_b64_tr_b16 a[96:97], v12 offset:2048
    ds_read_b64_tr_b16 a[98:99], v12 offset:22528
    ds_read_b64_tr_b16 a[104:105], v13 offset:2048
    ds_read_b64_tr_b16 a[106:107], v13 offset:22528
    ds_read_b64_tr_b16 a[112:113], v12 offset:3072
    ds_read_b64_tr_b16 a[114:115], v12 offset:23552
    ds_read_b64_tr_b16 a[120:121], v13 offset:3072
    ds_read_b64_tr_b16 a[122:123], v13 offset:23552
    ds_read_b64_tr_b16 a[128:129], v12 offset:4096
    ds_read_b64_tr_b16 a[130:131], v12 offset:24576
    ds_read_b64_tr_b16 a[136:137], v13 offset:4096
    ds_read_b64_tr_b16 a[138:139], v13 offset:24576
    ds_read_b64_tr_b16 a[68:69], v14 offset:0
    ds_read_b64_tr_b16 a[70:71], v14 offset:20480
    ds_read_b64_tr_b16 a[76:77], v11 offset:0
    ds_read_b64_tr_b16 a[78:79], v11 offset:20480
    ds_read_b64_tr_b16 a[84:85], v14 offset:1024
    ds_read_b64_tr_b16 a[86:87], v14 offset:21504
    ds_read_b64_tr_b16 a[92:93], v11 offset:1024
    ds_read_b64_tr_b16 a[94:95], v11 offset:21504
    ds_read_b64_tr_b16 a[100:101], v14 offset:2048
    ds_read_b64_tr_b16 a[102:103], v14 offset:22528
    ds_read_b64_tr_b16 a[108:109], v11 offset:2048
    ds_read_b64_tr_b16 a[110:111], v11 offset:22528
    ds_read_b64_tr_b16 a[116:117], v14 offset:3072
    ds_read_b64_tr_b16 a[118:119], v14 offset:23552
    ds_read_b64_tr_b16 a[124:125], v11 offset:3072
    ds_read_b64_tr_b16 a[126:127], v11 offset:23552
    ds_read_b64_tr_b16 a[132:133], v14 offset:4096
    ds_read_b64_tr_b16 a[134:135], v14 offset:24576
    ds_read_b64_tr_b16 a[140:141], v11 offset:4096
    ds_read_b64_tr_b16 a[142:143], v11 offset:24576
    s_waitcnt vmcnt(0)
    s_barrier
    ds_read_b64_tr_b16 v[32:33], v23 offset:0
    ds_read_b64_tr_b16 v[34:35], v23 offset:16896
    ds_read_b64_tr_b16 v[36:37], v23 offset:33792
    ds_read_b64_tr_b16 v[38:39], v23 offset:50688
    ds_read_b64_tr_b16 v[40:41], v23 offset:32
    ds_read_b64_tr_b16 v[42:43], v23 offset:16928
    ds_read_b64_tr_b16 v[44:45], v23 offset:33824
    ds_read_b64_tr_b16 v[46:47], v23 offset:50720
    ds_read_b64_tr_b16 v[48:49], v23 offset:64
    ds_read_b64_tr_b16 v[50:51], v23 offset:16960
    ds_read_b64_tr_b16 v[52:53], v23 offset:33856
    ds_read_b64_tr_b16 v[54:55], v23 offset:50752
    ds_read_b64_tr_b16 v[56:57], v23 offset:96
    ds_read_b64_tr_b16 v[58:59], v23 offset:16992
    ds_read_b64_tr_b16 v[60:61], v23 offset:33888
    ds_read_b64_tr_b16 v[62:63], v23 offset:50784
    ds_read_b64_tr_b16 v[64:65], v23 offset:128
    ds_read_b64_tr_b16 v[66:67], v23 offset:17024
    ds_read_b64_tr_b16 v[68:69], v23 offset:33920
    ds_read_b64_tr_b16 v[70:71], v23 offset:50816
    ds_read_b64_tr_b16 v[72:73], v23 offset:160
    ds_read_b64_tr_b16 v[74:75], v23 offset:17056
    ds_read_b64_tr_b16 v[76:77], v23 offset:33952
    ds_read_b64_tr_b16 v[78:79], v23 offset:50848
    ds_read_b64_tr_b16 v[80:81], v23 offset:192
    ds_read_b64_tr_b16 v[82:83], v23 offset:17088
    ds_read_b64_tr_b16 v[84:85], v23 offset:33984
    ds_read_b64_tr_b16 v[86:87], v23 offset:50880
    ds_read_b64_tr_b16 v[88:89], v23 offset:224
    ds_read_b64_tr_b16 v[90:91], v23 offset:17120
    ds_read_b64_tr_b16 v[92:93], v23 offset:34016
    ds_read_b64_tr_b16 v[94:95], v23 offset:50912
    s_waitcnt lgkmcnt(15)
    v_mfma_f32_16x16x32_bf16 v[128:131], v[32:35], v[96:99], 0
    v_mfma_f32_16x16x32_bf16 v[128:131], v[36:39], v[100:103], v[128:131]
    v_mfma_f32_16x16x32_bf16 v[132:135], v[40:43], v[96:99], 0
    v_mfma_f32_16x16x32_bf16 v[132:135], v[44:47], v[100:103], v[132:135]
    v_mfma_f32_16x16x32_bf16 v[136:139], v[48:51], v[96:99], 0
    v_mfma_f32_16x16x32_bf16 v[136:139], v[52:55], v[100:103], v[136:139]
    v_mfma_f32_16x16x32_bf16 v[140:143], v[56:59], v[96:99], 0
    v_mfma_f32_16x16x32_bf16 v[140:143], v[60:63], v[100:103], v[140:143]
    s_waitcnt lgkmcnt(14)
    v_mfma_f32_16x16x32_bf16 v[144:147], v[64:67], v[96:99], 0
    s_waitcnt lgkmcnt(12)
    v_mfma_f32_16x16x32_bf16 v[144:147], v[68:71], v[100:103], v[144:147]
    s_waitcnt lgkmcnt(10)
    v_mfma_f32_16x16x32_bf16 v[148:151], v[72:75], v[96:99], 0
    s_waitcnt lgkmcnt(8)
    v_mfma_f32_16x16x32_bf16 v[148:151], v[76:79], v[100:103], v[148:151]
    v_cvt_pk_bf16_f32 v160, v128, v129
    v_cvt_pk_bf16_f32 v161, v130, v131
    v_cvt_pk_bf16_f32 v162, v132, v133
    v_cvt_pk_bf16_f32 v163, v134, v135
    s_waitcnt lgkmcnt(6)
    v_mfma_f32_16x16x32_bf16 v[152:155], v[80:83], v[96:99], 0
    s_waitcnt lgkmcnt(4)
    v_mfma_f32_16x16x32_bf16 v[152:155], v[84:87], v[100:103], v[152:155]
    s_waitcnt lgkmcnt(2)
    v_mfma_f32_16x16x32_bf16 v[156:159], v[88:91], v[96:99], 0
    s_waitcnt lgkmcnt(0)
    v_mfma_f32_16x16x32_bf16 v[156:159], v[92:95], v[100:103], v[156:159]
    v_cvt_pk_bf16_f32 v164, v136, v137
    v_cvt_pk_bf16_f32 v165, v138, v139
    v_cvt_pk_bf16_f32 v166, v140, v141
    v_cvt_pk_bf16_f32 v167, v142, v143
    v_mfma_f32_16x16x32_bf16 v[176:179], v[160:163], a[0:3], 0
    v_mfma_f32_16x16x32_bf16 v[180:183], v[160:163], a[16:19], 0
    v_mfma_f32_16x16x32_bf16 v[184:187], v[160:163], a[32:35], 0
    v_mfma_f32_16x16x32_bf16 v[188:191], v[160:163], a[48:51], 0
    v_cvt_pk_bf16_f32 v168, v144, v145
    v_cvt_pk_bf16_f32 v169, v146, v147
    v_cvt_pk_bf16_f32 v170, v148, v149
    v_cvt_pk_bf16_f32 v171, v150, v151
    v_mfma_f32_16x16x32_bf16 v[176:179], v[164:167], a[4:7], v[176:179]
    v_mfma_f32_16x16x32_bf16 v[180:183], v[164:167], a[20:23], v[180:183]
    v_mfma_f32_16x16x32_bf16 v[184:187], v[164:167], a[36:39], v[184:187]
    v_mfma_f32_16x16x32_bf16 v[188:191], v[164:167], a[52:55], v[188:191]
    v_cvt_pk_bf16_f32 v172, v152, v153
    v_cvt_pk_bf16_f32 v173, v154, v155
    v_cvt_pk_bf16_f32 v174, v156, v157
    v_cvt_pk_bf16_f32 v175, v158, v159
    v_mfma_f32_16x16x32_bf16 v[176:179], v[168:171], a[8:11], v[176:179]
    v_mfma_f32_16x16x32_bf16 v[180:183], v[168:171], a[24:27], v[180:183]
    v_mfma_f32_16x16x32_bf16 v[184:187], v[168:171], a[40:43], v[184:187]
    v_mfma_f32_16x16x32_bf16 v[188:191], v[168:171], a[56:59], v[188:191]
    v_mfma_f32_16x16x32_bf16 v[176:179], v[172:175], a[12:15], v[176:179]
    v_mfma_f32_16x16x32_bf16 v[180:183], v[172:175], a[28:31], v[180:183]
    v_mfma_f32_16x16x32_bf16 v[184:187], v[172:175], a[44:47], v[184:187]
    v_mfma_f32_16x16x32_bf16 v[188:191], v[172:175], a[60:63], v[188:191]
    s_nop 5
    v_cndmask_b32 v192, v176, v180, s[56:57]
    s_nop 0
    v_cndmask_b32 v193, v184, v188, s[56:57]
    v_cndmask_b32 v192, v192, v193, s[58:59]
    ds_write_b32 v31, v192 offset:3840
    s_waitcnt lgkmcnt(0)
    s_barrier
    ds_read_b128 v[36:39], v30 offset:3840
    s_waitcnt lgkmcnt(0)
    v_add_f32 v36, v36, v37
    v_add_f32 v38, v38, v39
    v_add_f32 v36, v36, v38
    v_cvt_pk_bf16_f32 v36, v36, v36
    ds_write_b16 v28, v36 offset:4864
    s_waitcnt lgkmcnt(0)
    ds_read_b128 v[36:39], v29 offset:4864
    ds_read_b128 v[40:43], v29 offset:4928
    s_waitcnt lgkmcnt(0)
    v_mfma_f32_16x16x32_bf16 v[48:51], v[36:39], a[64:67], 0
    v_mfma_f32_16x16x32_bf16 v[48:51], v[40:43], a[68:71], v[48:51]
    v_mfma_f32_16x16x32_bf16 v[52:55], v[36:39], a[72:75], 0
    v_mfma_f32_16x16x32_bf16 v[52:55], v[40:43], a[76:79], v[52:55]
    v_mfma_f32_16x16x32_bf16 v[56:59], v[36:39], a[80:83], 0
    v_mfma_f32_16x16x32_bf16 v[56:59], v[40:43], a[84:87], v[56:59]
    v_mfma_f32_16x16x32_bf16 v[60:63], v[36:39], a[88:91], 0
    v_mfma_f32_16x16x32_bf16 v[60:63], v[40:43], a[92:95], v[60:63]
    v_mfma_f32_16x16x32_bf16 v[64:67], v[36:39], a[96:99], 0
    v_mfma_f32_16x16x32_bf16 v[64:67], v[40:43], a[100:103], v[64:67]
    v_mfma_f32_16x16x32_bf16 v[68:71], v[36:39], a[104:107], 0
    v_mfma_f32_16x16x32_bf16 v[68:71], v[40:43], a[108:111], v[68:71]
    v_cndmask_b32 v100, v48, v52, s[56:57]
    v_mfma_f32_16x16x32_bf16 v[72:75], v[36:39], a[112:115], 0
    s_nop 1
    v_cndmask_b32 v101, v56, v60, s[56:57]
    v_mfma_f32_16x16x32_bf16 v[72:75], v[40:43], a[116:119], v[72:75]
    v_cndmask_b32 v100, v100, v101, s[58:59]
    v_mfma_f32_16x16x32_bf16 v[76:79], v[36:39], a[120:123], 0
    v_min_u32 v100, -2, v100
    v_mfma_f32_16x16x32_bf16 v[76:79], v[40:43], a[124:127], v[76:79]
    buffer_store_dword v100, v19, s[28:31], s13 offen offset:0 sc1
    v_mfma_f32_16x16x32_bf16 v[80:83], v[36:39], a[128:131], 0
    v_mfma_f32_16x16x32_bf16 v[80:83], v[40:43], a[132:135], v[80:83]
    v_mfma_f32_16x16x32_bf16 v[84:87], v[36:39], a[136:139], 0
    v_mfma_f32_16x16x32_bf16 v[84:87], v[40:43], a[140:143], v[84:87]
    v_cndmask_b32 v102, v64, v68, s[56:57]
    s_nop 1
    v_cndmask_b32 v103, v72, v76, s[56:57]
    v_cndmask_b32 v102, v102, v103, s[58:59]
    v_min_u32 v102, -2, v102
    buffer_store_dword v102, v19, s[28:31], s13 offen offset:1024 sc1
    s_nop 0
    v_cndmask_b32 v104, v80, v84, s[56:57]
    v_min_u32 v104, -2, v104
    s_mov_b32 exec_hi, 0
    buffer_store_dword v104, v19, s[28:31], s13 offen offset:2048 sc1
    s_mov_b64 exec, -1
L_fin:
L_end:
    s_endpgm
.section .rodata,"a"
.p2align 6
.amdhsa_kernel concat_heads__compressed_kv_cla__compressed_kv_cla__decode_kernel
  .amdhsa_next_free_vgpr 512
  .amdhsa_next_free_sgpr 102
  .amdhsa_accum_offset 256
  .amdhsa_group_segment_fixed_size 0
  .amdhsa_kernarg_size 120
  .amdhsa_user_sgpr_count 2
  .amdhsa_user_sgpr_kernarg_segment_ptr 1
  .amdhsa_system_sgpr_workgroup_id_x 1
.end_amdhsa_kernel
```
